```python
import torch

def _softmax(x, axis=-1):
    return torch.softmax(x, dim=axis)
def _gelu(x):
    return torch.nn.functional.gelu(x, approximate="tanh")
def _silu(x):
    return torch.nn.functional.silu(x)
def _sigmoid(x):
    return torch.sigmoid(x)
def _layernorm(x, axis=-1, eps=1e-5):
    m = x.mean(dim=axis, keepdim=True)
    v = x.var(dim=axis, keepdim=True, unbiased=False)
    return (x - m) / torch.sqrt(v + eps)
def _scatter_add(tgt, idx, src, axis=0):
    return tgt.clone().index_add_(axis, idx, src)
def _segment_sum(src, seg, n):
    out = torch.zeros((n,) + src.shape[1:], dtype=src.dtype)
    return out.index_add_(0, seg, src)
def _pad(x, pw):
    flat = tuple(v for pair in reversed(pw) for v in pair)
    return torch.nn.functional.pad(x, flat)

kernel_name = 'parallel_sum__mha_block__mixer_channel_mlp__prompt'

def setup_inputs():

    _w = (lambda a: (lambda t: t.to(torch.bfloat16) if t.is_floating_point() else t)(torch.as_tensor(a)))
    def _A_setup():
        B, S, D, H = 1, 2048, 640, 32
        return {
            "x": _w((lambda *s: torch.randn(*s, dtype=torch.bfloat16) * 0.05)(B, S, D)),
            "wqkv": _w((lambda *s: torch.randn(*s, dtype=torch.bfloat16) * 0.05)(D, 3 * D)),
            "wo": _w((lambda *s: torch.randn(*s, dtype=torch.bfloat16) * 0.05)(D, D)),
        }
    _A_in = _A_setup()

    def _B_setup():
        B, S, D, F = 1, 2048, 640, 1536
        return {
            "x": _w((lambda *s: torch.randn(*s, dtype=torch.bfloat16) * 0.05)(B, S, D)),
            "w1": _w((lambda *s: torch.randn(*s, dtype=torch.bfloat16) * 3.2)(D, F) * (D ** -0.5)),
            "b1": _w((lambda *s: torch.randn(*s, dtype=torch.bfloat16) * 1.6)(F)),
            "w2": _w((lambda *s: torch.randn(*s, dtype=torch.bfloat16) * 0.1)(F, D) * (F ** -0.5)),
            "b2": _w((lambda *s: torch.randn(*s, dtype=torch.bfloat16) * 0.2)(D)),
        }
    _B_in = _B_setup()

    return {
        "A_x": _A_in["x"],
        "A_wqkv": _A_in["wqkv"],
        "A_wo": _A_in["wo"],
        "B_x": _B_in["x"],
        "B_w1": _B_in["w1"],
        "B_b1": _B_in["b1"],
        "B_w2": _B_in["w2"],
        "B_b2": _B_in["b2"],
    }

def reference(A_x, A_wqkv, A_wo, B_x, B_w1, B_b1, B_w2, B_b2):
    def _A_ref(x, wqkv, wo):
        B, S, D = x.shape
        H = 32
        Dh = D // H
        qkv = (lambda x, *d: x.permute(*d))((x @ wqkv).reshape(B, S, 3, H, Dh), 2, 0, 3, 1, 4)
        q, k, v = qkv[0], qkv[1], qkv[2]
        scores = torch.einsum("bhqd,bhkd->bhqk", q, k) * (Dh ** -0.5)
        p = _softmax(scores, axis=-1)
        o = torch.einsum("bhqk,bhkd->bhqd", p, v)
        return (lambda x, *d: x.permute(*d))(o, 0, 2, 1, 3).reshape(B, S, D) @ wo

    def _B_ref(x, w1, b1, w2, b2):
        y = _layernorm(x, axis=-1)
        h = _gelu(torch.einsum("bsd,df->bsf", y, w1) + b1)
        return torch.einsum("bsf,fd->bsd", h, w2) + b2

    x = A_x
    xn = _layernorm(x, axis=-1)
    return x + _A_ref(xn, A_wqkv, A_wo) + _B_ref(xn, B_w1, B_b1, B_w2, B_b2)
```

```asm
; @launch kernel=qkv_kernel grid=(256,1,1) block=(512,1,1) lds=149504
; @launch kernel=attn_kernel grid=(256,1,1) block=(768,1,1) lds=159744
.amdgcn_target "amdgcn-amd-amdhsa--gfx950"
.text
.globl qkv_kernel
.p2align 8
.type qkv_kernel,@function
qkv_kernel:
    s_cmp_ge_u32 s2, 256
    s_cbranch_scc1 L_k1_end
    s_load_dwordx4 s[4:7], s[0:1], 0
    s_load_dwordx4 s[36:39], s[0:1], 32
    s_load_dwordx2 s[40:41], s[0:1], 80
    v_and_b32 v1, 63, v0
    v_lshrrev_b32 v18, 6, v0
    s_and_b32 s28, s2, 7
    s_lshr_b32 s29, s2, 3
    v_readfirstlane_b32 s16, v18
    s_and_b32 s30, s28, 1
    s_lshl_b32 s30, s30, 3
    s_and_b32 s31, s29, 7
    s_add_u32 s19, s30, s31
    s_lshr_b32 s30, s28, 1
    s_lshl_b32 s30, s30, 1
    s_bfe_u32 s31, s29, 0x10003
    s_add_u32 s20, s30, s31
    s_lshr_b32 s23, s29, 4
    s_and_b32 s17, s16, 3
    s_lshr_b32 s18, s16, 2
    s_movk_i32 s22, 3840
    s_movk_i32 s31, 240
    s_sub_u32 s27, 8, s18
    s_cmp_lg_u32 s23, 0
    s_cselect_b32 s22, 3072, s22
    s_cselect_b32 s31, 192, s31
    s_cselect_b32 s27, 6, s27
    s_cselect_b32 s77, 12, 15
    s_cselect_b32 s78, 6, 8
    s_mul_i32 s21, s20, s31
    s_movk_i32 s67, 0x78
    v_lshrrev_b32 v18, 2, v1
    v_lshrrev_b32 v19, 4, v1
    v_lshlrev_b32 v192, 1, v19
    v_lshrrev_b32_e64 v192, v192, s67
    v_xor_b32 v192, v192, v1
    v_and_b32 v192, 3, v192
    v_mul_u32_u24 v4, 1280, v18
    v_lshl_add_u32 v4, v192, 4, v4
    s_lshl_b32 s28, s19, 3
    s_add_u32 s28, s28, s16
    s_mul_i32 s24, s28, 20480
    s_lshl_b32 s57, s16, 10
    s_add_u32 s57, s57, 16384
    s_lshl_b32 s56, s16, 11
    v_lshrrev_b32 v18, 5, v1
    s_and_b32 s28, s16, 3
    s_lshl_b32 s28, s28, 1
    v_add_u32 v20, s28, v18
    v_bfe_u32 v192, v1, 1, 4
    v_xor_b32 v192, v192, v20
    v_mul_lo_u32 v2, v18, s22
    v_lshl_add_u32 v2, v192, 5, v2
    v_and_b32 v193, 1, v1
    v_lshl_add_u32 v2, v193, 4, v2
    v_cmp_gt_u32 vcc, s77, v192
    v_mov_b32 v193, 0x7f000000
    s_lshl_b32 s29, s22, 2
    s_sub_u32 s29, s29, 1024
    v_cndmask_b32 v2, v193, v2, vcc
    s_and_b32 s28, s16, 1
    v_add_u32 v3, s29, v2
    s_lshl_b32 s28, s28, 1
    s_lshr_b32 s29, s16, 1
    s_lshl_b32 s29, s29, 3
    s_or_b32 s28, s28, s29
    s_mul_i32 s25, s28, s22
    s_lshl_b32 s29, s21, 1
    s_add_u32 s25, s25, s29
    s_lshl_b32 s26, s22, 5
    s_waitcnt lgkmcnt(0)
    s_mov_b32 s8, s4
    s_mov_b32 s9, s5
    s_mov_b32 s10, 2621440
    s_mov_b32 s11, 0x00020000
    s_cmp_lg_u32 s23, 0
    s_cselect_b32 s12, s36, s6
    s_cselect_b32 s13, s37, s7
    s_mul_i32 s14, s22, 640
    s_mov_b32 s15, 0x00020000
    s_add_u32 s58, s56, 0
    s_mov_b32 m0, s58
    s_add_u32 s59, s24, 0
    buffer_load_dwordx4 v2, s[12:15], s25 offen offset:0 lds
    buffer_load_dwordx4 v3, s[12:15], s25 offen offset:1024 lds
    s_add_u32 s58, s57, 0
    s_mov_b32 m0, s58
    s_add_u32 s25, s25, s26
    buffer_load_dwordx4 v4, s[8:11], s59 offen lds
    s_add_u32 s58, s56, 24576
    s_mov_b32 m0, s58
    s_add_u32 s59, s24, 64
    buffer_load_dwordx4 v2, s[12:15], s25 offen offset:0 lds
    buffer_load_dwordx4 v3, s[12:15], s25 offen offset:1024 lds
    s_add_u32 s58, s57, 24576
    s_mov_b32 m0, s58
    s_add_u32 s25, s25, s26
    buffer_load_dwordx4 v4, s[8:11], s59 offen lds
    s_mov_b32 s44, s40
    s_mov_b32 s45, s41
    s_mov_b32 s46, 9437184
    s_mov_b32 s47, 0x00020000
    s_add_u32 s48, s40, 9437184
    s_addc_u32 s49, s41, 0
    s_mov_b32 s50, 8912896
    s_mov_b32 s51, 0x00020000
    s_mov_b32 s52, s38
    s_mov_b32 s53, s39
    s_mov_b32 s54, 3072
    s_mov_b32 s55, 0x00020000
    v_and_b32 v18, 15, v1
    v_bfe_u32 v192, v1, 2, 2
    v_lshlrev_b32 v192, 1, v192
    v_lshrrev_b32_e64 v192, v192, s67
    v_xor_b32 v192, v192, v19
    v_and_b32 v192, 3, v192
    v_lshlrev_b32 v192, 4, v192
    v_lshl_add_u32 v192, v18, 6, v192
    s_lshl_b32 s28, s17, 11
    s_add_u32 s28, s28, 16384
    s_lshl_b32 s29, s18, 10
    s_add_u32 s30, s28, s29
    v_add_u32 v14, s30, v192
    s_xor_b32 s29, s29, 1024
    s_add_u32 s30, s28, s29
    v_add_u32 v15, s30, v192
    v_bfe_u32 v192, v1, 2, 1
    v_bfe_u32 v193, v1, 5, 1
    v_lshl_add_u32 v192, v193, 4, v192
    v_bfe_u32 v193, v1, 3, 1
    v_lshl_add_u32 v192, v193, 2, v192
    v_bfe_u32 v193, v1, 4, 1
    v_lshl_add_u32 v192, v193, 3, v192
    v_lshlrev_b32 v192, 9, v192
    v_bfe_u32 v194, v1, 2, 2
    v_lshl_add_u32 v194, v193, 2, v194
    v_lshl_add_u32 v192, v194, 5, v192
    v_and_b32 v194, 3, v1
    v_lshl_add_u32 v192, v194, 3, v192
    s_mul_i32 s28, s18, s78
    s_lshl_b32 s29, s17, 1
    s_add_u32 s30, s29, 0
    s_cmp_ge_u32 s30, s27
    s_cselect_b32 s31, s27, 0
    s_sub_u32 s30, s30, s31
    s_cmp_ge_u32 s30, s27
    s_cselect_b32 s31, s27, 0
    s_sub_u32 s30, s30, s31
    s_add_u32 s80, s30, s28
    s_lshl_b32 s30, s80, 5
    v_xor_b32 v6, s30, v192
    s_add_u32 s30, s29, 1
    s_cmp_ge_u32 s30, s27
    s_cselect_b32 s31, s27, 0
    s_sub_u32 s30, s30, s31
    s_cmp_ge_u32 s30, s27
    s_cselect_b32 s31, s27, 0
    s_sub_u32 s30, s30, s31
    s_add_u32 s81, s30, s28
    s_lshl_b32 s30, s81, 5
    v_xor_b32 v7, s30, v192
    s_add_u32 s30, s29, 2
    s_cmp_ge_u32 s30, s27
    s_cselect_b32 s31, s27, 0
    s_sub_u32 s30, s30, s31
    s_cmp_ge_u32 s30, s27
    s_cselect_b32 s31, s27, 0
    s_sub_u32 s30, s30, s31
    s_add_u32 s82, s30, s28
    s_lshl_b32 s30, s82, 5
    v_xor_b32 v8, s30, v192
    s_add_u32 s30, s29, 3
    s_cmp_ge_u32 s30, s27
    s_cselect_b32 s31, s27, 0
    s_sub_u32 s30, s30, s31
    s_cmp_ge_u32 s30, s27
    s_cselect_b32 s31, s27, 0
    s_sub_u32 s30, s30, s31
    s_add_u32 s83, s30, s28
    s_lshl_b32 s30, s83, 5
    v_xor_b32 v9, s30, v192
    s_add_u32 s30, s29, 4
    s_cmp_ge_u32 s30, s27
    s_cselect_b32 s31, s27, 0
    s_sub_u32 s30, s30, s31
    s_cmp_ge_u32 s30, s27
    s_cselect_b32 s31, s27, 0
    s_sub_u32 s30, s30, s31
    s_add_u32 s84, s30, s28
    s_lshl_b32 s30, s84, 5
    v_xor_b32 v10, s30, v192
    s_add_u32 s30, s29, 5
    s_cmp_ge_u32 s30, s27
    s_cselect_b32 s31, s27, 0
    s_sub_u32 s30, s30, s31
    s_cmp_ge_u32 s30, s27
    s_cselect_b32 s31, s27, 0
    s_sub_u32 s30, s30, s31
    s_add_u32 s85, s30, s28
    s_lshl_b32 s30, s85, 5
    v_xor_b32 v11, s30, v192
    s_add_u32 s30, s29, 6
    s_cmp_ge_u32 s30, s27
    s_cselect_b32 s31, s27, 0
    s_sub_u32 s30, s30, s31
    s_cmp_ge_u32 s30, s27
    s_cselect_b32 s31, s27, 0
    s_sub_u32 s30, s30, s31
    s_add_u32 s86, s30, s28
    s_lshl_b32 s30, s86, 5
    v_xor_b32 v12, s30, v192
    s_add_u32 s30, s29, 7
    s_cmp_ge_u32 s30, s27
    s_cselect_b32 s31, s27, 0
    s_sub_u32 s30, s30, s31
    s_cmp_ge_u32 s30, s27
    s_cselect_b32 s31, s27, 0
    s_sub_u32 s30, s30, s31
    s_add_u32 s87, s30, s28
    s_lshl_b32 s30, s87, 5
    v_xor_b32 v13, s30, v192
    v_add_u32 v236, 73728, v6
    v_add_u32 v237, 73728, v7
    v_add_u32 v238, 73728, v8
    v_add_u32 v239, 73728, v9
    v_add_u32 v240, 73728, v10
    v_add_u32 v241, 73728, v11
    v_add_u32 v242, 73728, v12
    v_add_u32 v243, 73728, v13
    v_add_u32 v244, 73728, v14
    v_add_u32 v245, 73728, v15
    s_lshl_b32 s28, s2, 4
    v_lshrrev_b32 v192, 4, v0
    v_add_u32 v192, s28, v192
    v_mul_u32_u24 v192, 1536, v192
    v_and_b32 v193, 15, v0
    v_lshl_add_u32 v192, v193, 4, v192
    v_add_u32 v192, 3147008, v192
    v_cmp_gt_u32 vcc, 256, v0
    v_mov_b32 v193, 0x7f000000
    v_mov_b32 v104, 0x3f803f80
    v_cndmask_b32 v192, v193, v192, vcc
    v_mov_b32 v105, 0
    v_mov_b32 v106, 0x3f803f80
    v_mov_b32 v107, 0
    buffer_store_dwordx4 v[104:107], v192, s[44:47], 0 offen
    s_add_u32 s68, s40, 0x1A00000
    s_addc_u32 s69, s41, 0
    s_mov_b32 s70, 8192
    s_mov_b32 s71, 0x00020000
    s_lshl_b32 s28, s2, 10
    v_mov_b32 v192, s28
    buffer_store_dword v105, v192, s[68:71], 0 offen
    s_lshl_b32 s28, s80, 4
    s_add_u32 s28, s28, s21
    s_lshl_b32 s28, s28, 1
    v_lshl_add_u32 v192, v19, 3, s28
    buffer_load_dwordx2 v[220:221], v192, s[52:55], 0 offen
    s_lshl_b32 s28, s81, 4
    s_add_u32 s28, s28, s21
    s_lshl_b32 s28, s28, 1
    v_lshl_add_u32 v192, v19, 3, s28
    buffer_load_dwordx2 v[222:223], v192, s[52:55], 0 offen
    s_lshl_b32 s28, s82, 4
    s_add_u32 s28, s28, s21
    s_lshl_b32 s28, s28, 1
    v_lshl_add_u32 v192, v19, 3, s28
    buffer_load_dwordx2 v[224:225], v192, s[52:55], 0 offen
    s_lshl_b32 s28, s83, 4
    s_add_u32 s28, s28, s21
    s_lshl_b32 s28, s28, 1
    v_lshl_add_u32 v192, v19, 3, s28
    buffer_load_dwordx2 v[226:227], v192, s[52:55], 0 offen
    s_lshl_b32 s28, s84, 4
    s_add_u32 s28, s28, s21
    s_lshl_b32 s28, s28, 1
    v_lshl_add_u32 v192, v19, 3, s28
    buffer_load_dwordx2 v[228:229], v192, s[52:55], 0 offen
    s_lshl_b32 s28, s85, 4
    s_add_u32 s28, s28, s21
    s_lshl_b32 s28, s28, 1
    v_lshl_add_u32 v192, v19, 3, s28
    buffer_load_dwordx2 v[230:231], v192, s[52:55], 0 offen
    v_mov_b32 v128, 0
    v_mov_b32 v129, 0
    v_mov_b32 v130, 0
    v_mov_b32 v131, 0
    v_mov_b32 v132, 0
    v_mov_b32 v133, 0
    v_mov_b32 v134, 0
    v_mov_b32 v135, 0
    v_mov_b32 v136, 0
    v_mov_b32 v137, 0
    v_mov_b32 v138, 0
    v_mov_b32 v139, 0
    v_mov_b32 v140, 0
    v_mov_b32 v141, 0
    v_mov_b32 v142, 0
    v_mov_b32 v143, 0
    v_mov_b32 v144, 0
    v_mov_b32 v145, 0
    v_mov_b32 v146, 0
    v_mov_b32 v147, 0
    v_mov_b32 v148, 0
    v_mov_b32 v149, 0
    v_mov_b32 v150, 0
    v_mov_b32 v151, 0
    v_mov_b32 v152, 0
    v_mov_b32 v153, 0
    v_mov_b32 v154, 0
    v_mov_b32 v155, 0
    v_mov_b32 v156, 0
    v_mov_b32 v157, 0
    v_mov_b32 v158, 0
    v_mov_b32 v159, 0
    v_mov_b32 v160, 0
    v_mov_b32 v161, 0
    v_mov_b32 v162, 0
    v_mov_b32 v163, 0
    v_mov_b32 v164, 0
    v_mov_b32 v165, 0
    v_mov_b32 v166, 0
    v_mov_b32 v167, 0
    v_mov_b32 v168, 0
    v_mov_b32 v169, 0
    v_mov_b32 v170, 0
    v_mov_b32 v171, 0
    v_mov_b32 v172, 0
    v_mov_b32 v173, 0
    v_mov_b32 v174, 0
    v_mov_b32 v175, 0
    v_mov_b32 v176, 0
    v_mov_b32 v177, 0
    v_mov_b32 v178, 0
    v_mov_b32 v179, 0
    v_mov_b32 v180, 0
    v_mov_b32 v181, 0
    v_mov_b32 v182, 0
    v_mov_b32 v183, 0
    v_mov_b32 v184, 0
    v_mov_b32 v185, 0
    v_mov_b32 v186, 0
    v_mov_b32 v187, 0
    v_mov_b32 v188, 0
    v_mov_b32 v189, 0
    v_mov_b32 v190, 0
    v_mov_b32 v191, 0
    v_mov_b32 v200, 0
    v_mov_b32 v201, 0
    v_mov_b32 v202, 0
    v_mov_b32 v203, 0
    v_mov_b32 v204, 0
    v_mov_b32 v205, 0
    v_mov_b32 v206, 0
    v_mov_b32 v207, 0
    v_mov_b32 v208, 0
    v_mov_b32 v209, 0
    v_mov_b32 v210, 0
    v_mov_b32 v211, 0
    v_mov_b32 v212, 0
    v_mov_b32 v213, 0
    v_mov_b32 v214, 0
    v_mov_b32 v215, 0
    v_mov_b32 v216, v104
    v_mov_b32 v217, v104
    v_mov_b32 v218, v104
    v_mov_b32 v219, v104
    s_add_u32 s58, s56, 49152
    s_mov_b32 m0, s58
    s_add_u32 s59, s24, 128
    buffer_load_dwordx4 v2, s[12:15], s25 offen offset:0 lds
    buffer_load_dwordx4 v3, s[12:15], s25 offen offset:1024 lds
    s_add_u32 s58, s57, 49152
    s_mov_b32 m0, s58
    s_add_u32 s25, s25, s26
    buffer_load_dwordx4 v4, s[8:11], s59 offen lds
    s_add_u32 s58, s56, 73728
    s_mov_b32 m0, s58
    s_add_u32 s59, s24, 192
    buffer_load_dwordx4 v2, s[12:15], s25 offen offset:0 lds
    buffer_load_dwordx4 v3, s[12:15], s25 offen offset:1024 lds
    s_add_u32 s58, s57, 73728
    s_mov_b32 m0, s58
    s_add_u32 s25, s25, s26
    buffer_load_dwordx4 v4, s[8:11], s59 offen lds
    s_add_u32 s58, s56, 98304
    s_mov_b32 m0, s58
    s_add_u32 s59, s24, 256
    buffer_load_dwordx4 v2, s[12:15], s25 offen offset:0 lds
    buffer_load_dwordx4 v3, s[12:15], s25 offen offset:1024 lds
    s_add_u32 s58, s57, 98304
    s_mov_b32 m0, s58
    s_add_u32 s25, s25, s26
    buffer_load_dwordx4 v4, s[8:11], s59 offen lds
    s_waitcnt vmcnt(20)
    s_barrier
    ds_read_b128 v[88:91], v14 offset:0
    ds_read_b128 v[92:95], v15 offset:0
    ds_read_b64_tr_b16 v[24:25], v6 offset:0
    ds_read_b64_tr_b16 v[26:27], v6 offset:1024
    ds_read_b64_tr_b16 v[28:29], v7 offset:0
    ds_read_b64_tr_b16 v[30:31], v7 offset:1024
    ds_read_b64_tr_b16 v[32:33], v8 offset:0
    ds_read_b64_tr_b16 v[34:35], v8 offset:1024
    ds_read_b64_tr_b16 v[36:37], v9 offset:0
    ds_read_b64_tr_b16 v[38:39], v9 offset:1024
    ds_read_b64_tr_b16 v[40:41], v10 offset:0
    ds_read_b64_tr_b16 v[42:43], v10 offset:1024
    ds_read_b64_tr_b16 v[44:45], v11 offset:0
    ds_read_b64_tr_b16 v[46:47], v11 offset:1024
    ds_read_b64_tr_b16 v[48:49], v12 offset:0
    ds_read_b64_tr_b16 v[50:51], v12 offset:1024
    ds_read_b64_tr_b16 v[52:53], v13 offset:0
    ds_read_b64_tr_b16 v[54:55], v13 offset:1024
    s_waitcnt vmcnt(17) lgkmcnt(0)
    s_barrier
    s_cmp_lt_u32 s27, 7
    s_cbranch_scc1 L_k1_t0
    v_mfma_f32_16x16x32_bf16 v[176:179], v[48:51], v[88:91], v[176:179]
    ds_read_b64_tr_b16 v[80:81], v12 offset:24576
    ds_read_b64_tr_b16 v[82:83], v12 offset:25600
    v_mfma_f32_16x16x32_bf16 v[180:183], v[48:51], v[92:95], v[180:183]
    s_cmp_lt_u32 s27, 8
    s_cbranch_scc1 L_k1_t0
    v_mfma_f32_16x16x32_bf16 v[184:187], v[52:55], v[88:91], v[184:187]
    ds_read_b64_tr_b16 v[84:85], v13 offset:24576
    ds_read_b64_tr_b16 v[86:87], v13 offset:25600
    v_mfma_f32_16x16x32_bf16 v[188:191], v[52:55], v[92:95], v[188:191]
L_k1_t0:
    v_mfma_f32_16x16x32_bf16 v[128:131], v[24:27], v[88:91], v[128:131]
    ds_read_b128 v[96:99], v14 offset:24576
    v_mfma_f32_16x16x32_bf16 v[132:135], v[24:27], v[92:95], v[132:135]
    ds_read_b128 v[100:103], v15 offset:24576
    v_mfma_f32_16x16x32_bf16 v[136:139], v[28:31], v[88:91], v[136:139]
    ds_read_b64_tr_b16 v[56:57], v6 offset:24576
    v_mfma_f32_16x16x32_bf16 v[140:143], v[28:31], v[92:95], v[140:143]
    ds_read_b64_tr_b16 v[58:59], v6 offset:25600
    v_mfma_f32_16x16x32_bf16 v[144:147], v[32:35], v[88:91], v[144:147]
    ds_read_b64_tr_b16 v[60:61], v7 offset:24576
    v_mfma_f32_16x16x32_bf16 v[148:151], v[32:35], v[92:95], v[148:151]
    ds_read_b64_tr_b16 v[62:63], v7 offset:25600
    s_add_u32 s58, s56, 122880
    v_mfma_f32_16x16x32_bf16 v[152:155], v[36:39], v[88:91], v[152:155]
    ds_read_b64_tr_b16 v[64:65], v8 offset:24576
    s_mov_b32 m0, s58
    v_mfma_f32_16x16x32_bf16 v[156:159], v[36:39], v[92:95], v[156:159]
    ds_read_b64_tr_b16 v[66:67], v8 offset:25600
    s_add_u32 s59, s24, 320
    v_mfma_f32_16x16x32_bf16 v[160:163], v[40:43], v[88:91], v[160:163]
    ds_read_b64_tr_b16 v[68:69], v9 offset:24576
    buffer_load_dwordx4 v2, s[12:15], s25 offen offset:0 lds
    v_mfma_f32_16x16x32_bf16 v[164:167], v[40:43], v[92:95], v[164:167]
    ds_read_b64_tr_b16 v[70:71], v9 offset:25600
    buffer_load_dwordx4 v3, s[12:15], s25 offen offset:1024 lds
    v_mfma_f32_16x16x32_bf16 v[168:171], v[44:47], v[88:91], v[168:171]
    ds_read_b64_tr_b16 v[72:73], v10 offset:24576
    s_add_u32 s58, s57, 122880
    v_mfma_f32_16x16x32_bf16 v[172:175], v[44:47], v[92:95], v[172:175]
    ds_read_b64_tr_b16 v[74:75], v10 offset:25600
    s_mov_b32 m0, s58
    v_mfma_f32_16x16x32_bf16 v[200:203], v[216:219], v[88:91], v[200:203]
    ds_read_b64_tr_b16 v[76:77], v11 offset:24576
    s_add_u32 s25, s25, s26
    v_mfma_f32_16x16x32_bf16 v[204:207], v[88:91], v[88:91], v[204:207]
    ds_read_b64_tr_b16 v[78:79], v11 offset:25600
    buffer_load_dwordx4 v4, s[8:11], s59 offen lds
    v_mfma_f32_16x16x32_bf16 v[208:211], v[24:27], v[216:219], v[208:211]
    v_mfma_f32_16x16x32_bf16 v[212:215], v[28:31], v[216:219], v[212:215]
    s_waitcnt vmcnt(9) lgkmcnt(0)
    s_barrier
    s_cmp_lt_u32 s27, 7
    s_cbranch_scc1 L_k1_t1
    v_mfma_f32_16x16x32_bf16 v[176:179], v[80:83], v[96:99], v[176:179]
    ds_read_b64_tr_b16 v[48:49], v12 offset:49152
    ds_read_b64_tr_b16 v[50:51], v12 offset:50176
    v_mfma_f32_16x16x32_bf16 v[180:183], v[80:83], v[100:103], v[180:183]
    s_cmp_lt_u32 s27, 8
    s_cbranch_scc1 L_k1_t1
    v_mfma_f32_16x16x32_bf16 v[184:187], v[84:87], v[96:99], v[184:187]
    ds_read_b64_tr_b16 v[52:53], v13 offset:49152
    ds_read_b64_tr_b16 v[54:55], v13 offset:50176
    v_mfma_f32_16x16x32_bf16 v[188:191], v[84:87], v[100:103], v[188:191]
L_k1_t1:
    v_mfma_f32_16x16x32_bf16 v[128:131], v[56:59], v[96:99], v[128:131]
    ds_read_b128 v[88:91], v14 offset:49152
    v_mfma_f32_16x16x32_bf16 v[132:135], v[56:59], v[100:103], v[132:135]
    ds_read_b128 v[92:95], v15 offset:49152
    v_mfma_f32_16x16x32_bf16 v[136:139], v[60:63], v[96:99], v[136:139]
    ds_read_b64_tr_b16 v[24:25], v6 offset:49152
    v_mfma_f32_16x16x32_bf16 v[140:143], v[60:63], v[100:103], v[140:143]
    ds_read_b64_tr_b16 v[26:27], v6 offset:50176
    v_mfma_f32_16x16x32_bf16 v[144:147], v[64:67], v[96:99], v[144:147]
    ds_read_b64_tr_b16 v[28:29], v7 offset:49152
    v_mfma_f32_16x16x32_bf16 v[148:151], v[64:67], v[100:103], v[148:151]
    ds_read_b64_tr_b16 v[30:31], v7 offset:50176
    s_add_u32 s58, s56, 0
    v_mfma_f32_16x16x32_bf16 v[152:155], v[68:71], v[96:99], v[152:155]
    ds_read_b64_tr_b16 v[32:33], v8 offset:49152
    s_mov_b32 m0, s58
    v_mfma_f32_16x16x32_bf16 v[156:159], v[68:71], v[100:103], v[156:159]
    ds_read_b64_tr_b16 v[34:35], v8 offset:50176
    s_add_u32 s59, s24, 384
    v_mfma_f32_16x16x32_bf16 v[160:163], v[72:75], v[96:99], v[160:163]
    ds_read_b64_tr_b16 v[36:37], v9 offset:49152
    buffer_load_dwordx4 v2, s[12:15], s25 offen offset:0 lds
    v_mfma_f32_16x16x32_bf16 v[164:167], v[72:75], v[100:103], v[164:167]
    ds_read_b64_tr_b16 v[38:39], v9 offset:50176
    buffer_load_dwordx4 v3, s[12:15], s25 offen offset:1024 lds
    v_mfma_f32_16x16x32_bf16 v[168:171], v[76:79], v[96:99], v[168:171]
    ds_read_b64_tr_b16 v[40:41], v10 offset:49152
    s_add_u32 s58, s57, 0
    v_mfma_f32_16x16x32_bf16 v[172:175], v[76:79], v[100:103], v[172:175]
    ds_read_b64_tr_b16 v[42:43], v10 offset:50176
    s_mov_b32 m0, s58
    v_mfma_f32_16x16x32_bf16 v[200:203], v[216:219], v[96:99], v[200:203]
    ds_read_b64_tr_b16 v[44:45], v11 offset:49152
    s_add_u32 s25, s25, s26
    v_mfma_f32_16x16x32_bf16 v[204:207], v[96:99], v[96:99], v[204:207]
    ds_read_b64_tr_b16 v[46:47], v11 offset:50176
    buffer_load_dwordx4 v4, s[8:11], s59 offen lds
    v_mfma_f32_16x16x32_bf16 v[208:211], v[56:59], v[216:219], v[208:211]
    v_mfma_f32_16x16x32_bf16 v[212:215], v[60:63], v[216:219], v[212:215]
    s_waitcnt vmcnt(9) lgkmcnt(0)
    s_barrier
    s_cmp_lt_u32 s27, 7
    s_cbranch_scc1 L_k1_t2
    v_mfma_f32_16x16x32_bf16 v[176:179], v[48:51], v[88:91], v[176:179]
    ds_read_b64_tr_b16 v[80:81], v242 offset:0
    ds_read_b64_tr_b16 v[82:83], v242 offset:1024
    v_mfma_f32_16x16x32_bf16 v[180:183], v[48:51], v[92:95], v[180:183]
    s_cmp_lt_u32 s27, 8
    s_cbranch_scc1 L_k1_t2
    v_mfma_f32_16x16x32_bf16 v[184:187], v[52:55], v[88:91], v[184:187]
    ds_read_b64_tr_b16 v[84:85], v243 offset:0
    ds_read_b64_tr_b16 v[86:87], v243 offset:1024
    v_mfma_f32_16x16x32_bf16 v[188:191], v[52:55], v[92:95], v[188:191]
L_k1_t2:
    v_mfma_f32_16x16x32_bf16 v[128:131], v[24:27], v[88:91], v[128:131]
    ds_read_b128 v[96:99], v244 offset:0
    v_mfma_f32_16x16x32_bf16 v[132:135], v[24:27], v[92:95], v[132:135]
    ds_read_b128 v[100:103], v245 offset:0
    v_mfma_f32_16x16x32_bf16 v[136:139], v[28:31], v[88:91], v[136:139]
    ds_read_b64_tr_b16 v[56:57], v236 offset:0
    v_mfma_f32_16x16x32_bf16 v[140:143], v[28:31], v[92:95], v[140:143]
    ds_read_b64_tr_b16 v[58:59], v236 offset:1024
    v_mfma_f32_16x16x32_bf16 v[144:147], v[32:35], v[88:91], v[144:147]
    ds_read_b64_tr_b16 v[60:61], v237 offset:0
    v_mfma_f32_16x16x32_bf16 v[148:151], v[32:35], v[92:95], v[148:151]
    ds_read_b64_tr_b16 v[62:63], v237 offset:1024
    s_add_u32 s58, s56, 24576
    v_mfma_f32_16x16x32_bf16 v[152:155], v[36:39], v[88:91], v[152:155]
    ds_read_b64_tr_b16 v[64:65], v238 offset:0
    s_mov_b32 m0, s58
    v_mfma_f32_16x16x32_bf16 v[156:159], v[36:39], v[92:95], v[156:159]
    ds_read_b64_tr_b16 v[66:67], v238 offset:1024
    s_add_u32 s59, s24, 448
    v_mfma_f32_16x16x32_bf16 v[160:163], v[40:43], v[88:91], v[160:163]
    ds_read_b64_tr_b16 v[68:69], v239 offset:0
    buffer_load_dwordx4 v2, s[12:15], s25 offen offset:0 lds
    v_mfma_f32_16x16x32_bf16 v[164:167], v[40:43], v[92:95], v[164:167]
    ds_read_b64_tr_b16 v[70:71], v239 offset:1024
    buffer_load_dwordx4 v3, s[12:15], s25 offen offset:1024 lds
    v_mfma_f32_16x16x32_bf16 v[168:171], v[44:47], v[88:91], v[168:171]
    ds_read_b64_tr_b16 v[72:73], v240 offset:0
    s_add_u32 s58, s57, 24576
    v_mfma_f32_16x16x32_bf16 v[172:175], v[44:47], v[92:95], v[172:175]
    ds_read_b64_tr_b16 v[74:75], v240 offset:1024
    s_mov_b32 m0, s58
    v_mfma_f32_16x16x32_bf16 v[200:203], v[216:219], v[88:91], v[200:203]
    ds_read_b64_tr_b16 v[76:77], v241 offset:0
    s_add_u32 s25, s25, s26
    v_mfma_f32_16x16x32_bf16 v[204:207], v[88:91], v[88:91], v[204:207]
    ds_read_b64_tr_b16 v[78:79], v241 offset:1024
    buffer_load_dwordx4 v4, s[8:11], s59 offen lds
    v_mfma_f32_16x16x32_bf16 v[208:211], v[24:27], v[216:219], v[208:211]
    v_mfma_f32_16x16x32_bf16 v[212:215], v[28:31], v[216:219], v[212:215]
    s_waitcnt vmcnt(9) lgkmcnt(0)
    s_barrier
    s_cmp_lt_u32 s27, 7
    s_cbranch_scc1 L_k1_t3
    v_mfma_f32_16x16x32_bf16 v[176:179], v[80:83], v[96:99], v[176:179]
    ds_read_b64_tr_b16 v[48:49], v242 offset:24576
    ds_read_b64_tr_b16 v[50:51], v242 offset:25600
    v_mfma_f32_16x16x32_bf16 v[180:183], v[80:83], v[100:103], v[180:183]
    s_cmp_lt_u32 s27, 8
    s_cbranch_scc1 L_k1_t3
    v_mfma_f32_16x16x32_bf16 v[184:187], v[84:87], v[96:99], v[184:187]
    ds_read_b64_tr_b16 v[52:53], v243 offset:24576
    ds_read_b64_tr_b16 v[54:55], v243 offset:25600
    v_mfma_f32_16x16x32_bf16 v[188:191], v[84:87], v[100:103], v[188:191]
L_k1_t3:
    v_mfma_f32_16x16x32_bf16 v[128:131], v[56:59], v[96:99], v[128:131]
    ds_read_b128 v[88:91], v244 offset:24576
    v_mfma_f32_16x16x32_bf16 v[132:135], v[56:59], v[100:103], v[132:135]
    ds_read_b128 v[92:95], v245 offset:24576
    v_mfma_f32_16x16x32_bf16 v[136:139], v[60:63], v[96:99], v[136:139]
    ds_read_b64_tr_b16 v[24:25], v236 offset:24576
    v_mfma_f32_16x16x32_bf16 v[140:143], v[60:63], v[100:103], v[140:143]
    ds_read_b64_tr_b16 v[26:27], v236 offset:25600
    v_mfma_f32_16x16x32_bf16 v[144:147], v[64:67], v[96:99], v[144:147]
    ds_read_b64_tr_b16 v[28:29], v237 offset:24576
    v_mfma_f32_16x16x32_bf16 v[148:151], v[64:67], v[100:103], v[148:151]
    ds_read_b64_tr_b16 v[30:31], v237 offset:25600
    s_add_u32 s58, s56, 49152
    v_mfma_f32_16x16x32_bf16 v[152:155], v[68:71], v[96:99], v[152:155]
    ds_read_b64_tr_b16 v[32:33], v238 offset:24576
    s_mov_b32 m0, s58
    v_mfma_f32_16x16x32_bf16 v[156:159], v[68:71], v[100:103], v[156:159]
    ds_read_b64_tr_b16 v[34:35], v238 offset:25600
    s_add_u32 s59, s24, 512
    v_mfma_f32_16x16x32_bf16 v[160:163], v[72:75], v[96:99], v[160:163]
    ds_read_b64_tr_b16 v[36:37], v239 offset:24576
    buffer_load_dwordx4 v2, s[12:15], s25 offen offset:0 lds
    v_mfma_f32_16x16x32_bf16 v[164:167], v[72:75], v[100:103], v[164:167]
    ds_read_b64_tr_b16 v[38:39], v239 offset:25600
    buffer_load_dwordx4 v3, s[12:15], s25 offen offset:1024 lds
    v_mfma_f32_16x16x32_bf16 v[168:171], v[76:79], v[96:99], v[168:171]
    ds_read_b64_tr_b16 v[40:41], v240 offset:24576
    s_add_u32 s58, s57, 49152
    v_mfma_f32_16x16x32_bf16 v[172:175], v[76:79], v[100:103], v[172:175]
    ds_read_b64_tr_b16 v[42:43], v240 offset:25600
    s_mov_b32 m0, s58
    v_mfma_f32_16x16x32_bf16 v[200:203], v[216:219], v[96:99], v[200:203]
    ds_read_b64_tr_b16 v[44:45], v241 offset:24576
    s_add_u32 s25, s25, s26
    v_mfma_f32_16x16x32_bf16 v[204:207], v[96:99], v[96:99], v[204:207]
    ds_read_b64_tr_b16 v[46:47], v241 offset:25600
    buffer_load_dwordx4 v4, s[8:11], s59 offen lds
    v_mfma_f32_16x16x32_bf16 v[208:211], v[56:59], v[216:219], v[208:211]
    v_mfma_f32_16x16x32_bf16 v[212:215], v[60:63], v[216:219], v[212:215]
    s_waitcnt vmcnt(9) lgkmcnt(0)
    s_barrier
    s_cmp_lt_u32 s27, 7
    s_cbranch_scc1 L_k1_t4
    v_mfma_f32_16x16x32_bf16 v[176:179], v[48:51], v[88:91], v[176:179]
    ds_read_b64_tr_b16 v[80:81], v242 offset:49152
    ds_read_b64_tr_b16 v[82:83], v242 offset:50176
    v_mfma_f32_16x16x32_bf16 v[180:183], v[48:51], v[92:95], v[180:183]
    s_cmp_lt_u32 s27, 8
    s_cbranch_scc1 L_k1_t4
    v_mfma_f32_16x16x32_bf16 v[184:187], v[52:55], v[88:91], v[184:187]
    ds_read_b64_tr_b16 v[84:85], v243 offset:49152
    ds_read_b64_tr_b16 v[86:87], v243 offset:50176
    v_mfma_f32_16x16x32_bf16 v[188:191], v[52:55], v[92:95], v[188:191]
L_k1_t4:
    v_mfma_f32_16x16x32_bf16 v[128:131], v[24:27], v[88:91], v[128:131]
    ds_read_b128 v[96:99], v244 offset:49152
    v_mfma_f32_16x16x32_bf16 v[132:135], v[24:27], v[92:95], v[132:135]
    ds_read_b128 v[100:103], v245 offset:49152
    v_mfma_f32_16x16x32_bf16 v[136:139], v[28:31], v[88:91], v[136:139]
    ds_read_b64_tr_b16 v[56:57], v236 offset:49152
    v_mfma_f32_16x16x32_bf16 v[140:143], v[28:31], v[92:95], v[140:143]
    ds_read_b64_tr_b16 v[58:59], v236 offset:50176
    v_mfma_f32_16x16x32_bf16 v[144:147], v[32:35], v[88:91], v[144:147]
    ds_read_b64_tr_b16 v[60:61], v237 offset:49152
    v_mfma_f32_16x16x32_bf16 v[148:151], v[32:35], v[92:95], v[148:151]
    ds_read_b64_tr_b16 v[62:63], v237 offset:50176
    s_add_u32 s58, s56, 73728
    v_mfma_f32_16x16x32_bf16 v[152:155], v[36:39], v[88:91], v[152:155]
    ds_read_b64_tr_b16 v[64:65], v238 offset:49152
    s_mov_b32 m0, s58
    v_mfma_f32_16x16x32_bf16 v[156:159], v[36:39], v[92:95], v[156:159]
    ds_read_b64_tr_b16 v[66:67], v238 offset:50176
    s_add_u32 s59, s24, 576
    v_mfma_f32_16x16x32_bf16 v[160:163], v[40:43], v[88:91], v[160:163]
    ds_read_b64_tr_b16 v[68:69], v239 offset:49152
    buffer_load_dwordx4 v2, s[12:15], s25 offen offset:0 lds
    v_mfma_f32_16x16x32_bf16 v[164:167], v[40:43], v[92:95], v[164:167]
    ds_read_b64_tr_b16 v[70:71], v239 offset:50176
    buffer_load_dwordx4 v3, s[12:15], s25 offen offset:1024 lds
    v_mfma_f32_16x16x32_bf16 v[168:171], v[44:47], v[88:91], v[168:171]
    ds_read_b64_tr_b16 v[72:73], v240 offset:49152
    s_add_u32 s58, s57, 73728
    v_mfma_f32_16x16x32_bf16 v[172:175], v[44:47], v[92:95], v[172:175]
    ds_read_b64_tr_b16 v[74:75], v240 offset:50176
    s_mov_b32 m0, s58
    v_mfma_f32_16x16x32_bf16 v[200:203], v[216:219], v[88:91], v[200:203]
    ds_read_b64_tr_b16 v[76:77], v241 offset:49152
    s_add_u32 s25, s25, s26
    v_mfma_f32_16x16x32_bf16 v[204:207], v[88:91], v[88:91], v[204:207]
    ds_read_b64_tr_b16 v[78:79], v241 offset:50176
    buffer_load_dwordx4 v4, s[8:11], s59 offen lds
    v_mfma_f32_16x16x32_bf16 v[208:211], v[24:27], v[216:219], v[208:211]
    v_mfma_f32_16x16x32_bf16 v[212:215], v[28:31], v[216:219], v[212:215]
    s_waitcnt vmcnt(9) lgkmcnt(0)
    s_barrier
    s_cmp_lt_u32 s27, 7
    s_cbranch_scc1 L_k1_t5
    v_mfma_f32_16x16x32_bf16 v[176:179], v[80:83], v[96:99], v[176:179]
    ds_read_b64_tr_b16 v[48:49], v12 offset:0
    ds_read_b64_tr_b16 v[50:51], v12 offset:1024
    v_mfma_f32_16x16x32_bf16 v[180:183], v[80:83], v[100:103], v[180:183]
    s_cmp_lt_u32 s27, 8
    s_cbranch_scc1 L_k1_t5
    v_mfma_f32_16x16x32_bf16 v[184:187], v[84:87], v[96:99], v[184:187]
    ds_read_b64_tr_b16 v[52:53], v13 offset:0
    ds_read_b64_tr_b16 v[54:55], v13 offset:1024
    v_mfma_f32_16x16x32_bf16 v[188:191], v[84:87], v[100:103], v[188:191]
L_k1_t5:
    v_mfma_f32_16x16x32_bf16 v[128:131], v[56:59], v[96:99], v[128:131]
    ds_read_b128 v[88:91], v14 offset:0
    v_mfma_f32_16x16x32_bf16 v[132:135], v[56:59], v[100:103], v[132:135]
    ds_read_b128 v[92:95], v15 offset:0
    v_mfma_f32_16x16x32_bf16 v[136:139], v[60:63], v[96:99], v[136:139]
    ds_read_b64_tr_b16 v[24:25], v6 offset:0
    v_mfma_f32_16x16x32_bf16 v[140:143], v[60:63], v[100:103], v[140:143]
    ds_read_b64_tr_b16 v[26:27], v6 offset:1024
    v_mfma_f32_16x16x32_bf16 v[144:147], v[64:67], v[96:99], v[144:147]
    ds_read_b64_tr_b16 v[28:29], v7 offset:0
    v_mfma_f32_16x16x32_bf16 v[148:151], v[64:67], v[100:103], v[148:151]
    ds_read_b64_tr_b16 v[30:31], v7 offset:1024
    s_add_u32 s58, s56, 98304
    v_mfma_f32_16x16x32_bf16 v[152:155], v[68:71], v[96:99], v[152:155]
    ds_read_b64_tr_b16 v[32:33], v8 offset:0
    s_mov_b32 m0, s58
    v_mfma_f32_16x16x32_bf16 v[156:159], v[68:71], v[100:103], v[156:159]
    ds_read_b64_tr_b16 v[34:35], v8 offset:1024
    s_add_u32 s59, s24, 640
    v_mfma_f32_16x16x32_bf16 v[160:163], v[72:75], v[96:99], v[160:163]
    ds_read_b64_tr_b16 v[36:37], v9 offset:0
    buffer_load_dwordx4 v2, s[12:15], s25 offen offset:0 lds
    v_mfma_f32_16x16x32_bf16 v[164:167], v[72:75], v[100:103], v[164:167]
    ds_read_b64_tr_b16 v[38:39], v9 offset:1024
    buffer_load_dwordx4 v3, s[12:15], s25 offen offset:1024 lds
    v_mfma_f32_16x16x32_bf16 v[168:171], v[76:79], v[96:99], v[168:171]
    ds_read_b64_tr_b16 v[40:41], v10 offset:0
    s_add_u32 s58, s57, 98304
    v_mfma_f32_16x16x32_bf16 v[172:175], v[76:79], v[100:103], v[172:175]
    ds_read_b64_tr_b16 v[42:43], v10 offset:1024
    s_mov_b32 m0, s58
    v_mfma_f32_16x16x32_bf16 v[200:203], v[216:219], v[96:99], v[200:203]
    ds_read_b64_tr_b16 v[44:45], v11 offset:0
    s_add_u32 s25, s25, s26
    v_mfma_f32_16x16x32_bf16 v[204:207], v[96:99], v[96:99], v[204:207]
    ds_read_b64_tr_b16 v[46:47], v11 offset:1024
    buffer_load_dwordx4 v4, s[8:11], s59 offen lds
    v_mfma_f32_16x16x32_bf16 v[208:211], v[56:59], v[216:219], v[208:211]
    v_mfma_f32_16x16x32_bf16 v[212:215], v[60:63], v[216:219], v[212:215]
    s_waitcnt vmcnt(9) lgkmcnt(0)
    s_barrier
    s_cmp_lt_u32 s27, 7
    s_cbranch_scc1 L_k1_t6
    v_mfma_f32_16x16x32_bf16 v[176:179], v[48:51], v[88:91], v[176:179]
    ds_read_b64_tr_b16 v[80:81], v12 offset:24576
    ds_read_b64_tr_b16 v[82:83], v12 offset:25600
    v_mfma_f32_16x16x32_bf16 v[180:183], v[48:51], v[92:95], v[180:183]
    s_cmp_lt_u32 s27, 8
    s_cbranch_scc1 L_k1_t6
    v_mfma_f32_16x16x32_bf16 v[184:187], v[52:55], v[88:91], v[184:187]
    ds_read_b64_tr_b16 v[84:85], v13 offset:24576
    ds_read_b64_tr_b16 v[86:87], v13 offset:25600
    v_mfma_f32_16x16x32_bf16 v[188:191], v[52:55], v[92:95], v[188:191]
L_k1_t6:
    v_mfma_f32_16x16x32_bf16 v[128:131], v[24:27], v[88:91], v[128:131]
    ds_read_b128 v[96:99], v14 offset:24576
    v_mfma_f32_16x16x32_bf16 v[132:135], v[24:27], v[92:95], v[132:135]
    ds_read_b128 v[100:103], v15 offset:24576
    v_mfma_f32_16x16x32_bf16 v[136:139], v[28:31], v[88:91], v[136:139]
    ds_read_b64_tr_b16 v[56:57], v6 offset:24576
    v_mfma_f32_16x16x32_bf16 v[140:143], v[28:31], v[92:95], v[140:143]
    ds_read_b64_tr_b16 v[58:59], v6 offset:25600
    v_mfma_f32_16x16x32_bf16 v[144:147], v[32:35], v[88:91], v[144:147]
    ds_read_b64_tr_b16 v[60:61], v7 offset:24576
    v_mfma_f32_16x16x32_bf16 v[148:151], v[32:35], v[92:95], v[148:151]
    ds_read_b64_tr_b16 v[62:63], v7 offset:25600
    s_add_u32 s58, s56, 122880
    v_mfma_f32_16x16x32_bf16 v[152:155], v[36:39], v[88:91], v[152:155]
    ds_read_b64_tr_b16 v[64:65], v8 offset:24576
    s_mov_b32 m0, s58
    v_mfma_f32_16x16x32_bf16 v[156:159], v[36:39], v[92:95], v[156:159]
    ds_read_b64_tr_b16 v[66:67], v8 offset:25600
    s_add_u32 s59, s24, 704
    v_mfma_f32_16x16x32_bf16 v[160:163], v[40:43], v[88:91], v[160:163]
    ds_read_b64_tr_b16 v[68:69], v9 offset:24576
    buffer_load_dwordx4 v2, s[12:15], s25 offen offset:0 lds
    v_mfma_f32_16x16x32_bf16 v[164:167], v[40:43], v[92:95], v[164:167]
    ds_read_b64_tr_b16 v[70:71], v9 offset:25600
    buffer_load_dwordx4 v3, s[12:15], s25 offen offset:1024 lds
    v_mfma_f32_16x16x32_bf16 v[168:171], v[44:47], v[88:91], v[168:171]
    ds_read_b64_tr_b16 v[72:73], v10 offset:24576
    s_add_u32 s58, s57, 122880
    v_mfma_f32_16x16x32_bf16 v[172:175], v[44:47], v[92:95], v[172:175]
    ds_read_b64_tr_b16 v[74:75], v10 offset:25600
    s_mov_b32 m0, s58
    v_mfma_f32_16x16x32_bf16 v[200:203], v[216:219], v[88:91], v[200:203]
    ds_read_b64_tr_b16 v[76:77], v11 offset:24576
    s_add_u32 s25, s25, s26
    v_mfma_f32_16x16x32_bf16 v[204:207], v[88:91], v[88:91], v[204:207]
    ds_read_b64_tr_b16 v[78:79], v11 offset:25600
    buffer_load_dwordx4 v4, s[8:11], s59 offen lds
    v_mfma_f32_16x16x32_bf16 v[208:211], v[24:27], v[216:219], v[208:211]
    v_mfma_f32_16x16x32_bf16 v[212:215], v[28:31], v[216:219], v[212:215]
    s_waitcnt vmcnt(9) lgkmcnt(0)
    s_barrier
    s_cmp_lt_u32 s27, 7
    s_cbranch_scc1 L_k1_t7
    v_mfma_f32_16x16x32_bf16 v[176:179], v[80:83], v[96:99], v[176:179]
    ds_read_b64_tr_b16 v[48:49], v12 offset:49152
    ds_read_b64_tr_b16 v[50:51], v12 offset:50176
    v_mfma_f32_16x16x32_bf16 v[180:183], v[80:83], v[100:103], v[180:183]
    s_cmp_lt_u32 s27, 8
    s_cbranch_scc1 L_k1_t7
    v_mfma_f32_16x16x32_bf16 v[184:187], v[84:87], v[96:99], v[184:187]
    ds_read_b64_tr_b16 v[52:53], v13 offset:49152
    ds_read_b64_tr_b16 v[54:55], v13 offset:50176
    v_mfma_f32_16x16x32_bf16 v[188:191], v[84:87], v[100:103], v[188:191]
L_k1_t7:
    v_mfma_f32_16x16x32_bf16 v[128:131], v[56:59], v[96:99], v[128:131]
    ds_read_b128 v[88:91], v14 offset:49152
    v_mfma_f32_16x16x32_bf16 v[132:135], v[56:59], v[100:103], v[132:135]
    ds_read_b128 v[92:95], v15 offset:49152
    v_mfma_f32_16x16x32_bf16 v[136:139], v[60:63], v[96:99], v[136:139]
    ds_read_b64_tr_b16 v[24:25], v6 offset:49152
    v_mfma_f32_16x16x32_bf16 v[140:143], v[60:63], v[100:103], v[140:143]
    ds_read_b64_tr_b16 v[26:27], v6 offset:50176
    v_mfma_f32_16x16x32_bf16 v[144:147], v[64:67], v[96:99], v[144:147]
    ds_read_b64_tr_b16 v[28:29], v7 offset:49152
    v_mfma_f32_16x16x32_bf16 v[148:151], v[64:67], v[100:103], v[148:151]
    ds_read_b64_tr_b16 v[30:31], v7 offset:50176
    s_add_u32 s58, s56, 0
    v_mfma_f32_16x16x32_bf16 v[152:155], v[68:71], v[96:99], v[152:155]
    ds_read_b64_tr_b16 v[32:33], v8 offset:49152
    s_mov_b32 m0, s58
    v_mfma_f32_16x16x32_bf16 v[156:159], v[68:71], v[100:103], v[156:159]
    ds_read_b64_tr_b16 v[34:35], v8 offset:50176
    s_add_u32 s59, s24, 768
    v_mfma_f32_16x16x32_bf16 v[160:163], v[72:75], v[96:99], v[160:163]
    ds_read_b64_tr_b16 v[36:37], v9 offset:49152
    buffer_load_dwordx4 v2, s[12:15], s25 offen offset:0 lds
    v_mfma_f32_16x16x32_bf16 v[164:167], v[72:75], v[100:103], v[164:167]
    ds_read_b64_tr_b16 v[38:39], v9 offset:50176
    buffer_load_dwordx4 v3, s[12:15], s25 offen offset:1024 lds
    v_mfma_f32_16x16x32_bf16 v[168:171], v[76:79], v[96:99], v[168:171]
    ds_read_b64_tr_b16 v[40:41], v10 offset:49152
    s_add_u32 s58, s57, 0
    v_mfma_f32_16x16x32_bf16 v[172:175], v[76:79], v[100:103], v[172:175]
    ds_read_b64_tr_b16 v[42:43], v10 offset:50176
    s_mov_b32 m0, s58
    v_mfma_f32_16x16x32_bf16 v[200:203], v[216:219], v[96:99], v[200:203]
    ds_read_b64_tr_b16 v[44:45], v11 offset:49152
    s_add_u32 s25, s25, s26
    v_mfma_f32_16x16x32_bf16 v[204:207], v[96:99], v[96:99], v[204:207]
    ds_read_b64_tr_b16 v[46:47], v11 offset:50176
    buffer_load_dwordx4 v4, s[8:11], s59 offen lds
    v_mfma_f32_16x16x32_bf16 v[208:211], v[56:59], v[216:219], v[208:211]
    v_mfma_f32_16x16x32_bf16 v[212:215], v[60:63], v[216:219], v[212:215]
    s_waitcnt vmcnt(9) lgkmcnt(0)
    s_barrier
    s_cmp_lt_u32 s27, 7
    s_cbranch_scc1 L_k1_t8
    v_mfma_f32_16x16x32_bf16 v[176:179], v[48:51], v[88:91], v[176:179]
    ds_read_b64_tr_b16 v[80:81], v242 offset:0
    ds_read_b64_tr_b16 v[82:83], v242 offset:1024
    v_mfma_f32_16x16x32_bf16 v[180:183], v[48:51], v[92:95], v[180:183]
    s_cmp_lt_u32 s27, 8
    s_cbranch_scc1 L_k1_t8
    v_mfma_f32_16x16x32_bf16 v[184:187], v[52:55], v[88:91], v[184:187]
    ds_read_b64_tr_b16 v[84:85], v243 offset:0
    ds_read_b64_tr_b16 v[86:87], v243 offset:1024
    v_mfma_f32_16x16x32_bf16 v[188:191], v[52:55], v[92:95], v[188:191]
L_k1_t8:
    v_mfma_f32_16x16x32_bf16 v[128:131], v[24:27], v[88:91], v[128:131]
    ds_read_b128 v[96:99], v244 offset:0
    v_mfma_f32_16x16x32_bf16 v[132:135], v[24:27], v[92:95], v[132:135]
    ds_read_b128 v[100:103], v245 offset:0
    v_mfma_f32_16x16x32_bf16 v[136:139], v[28:31], v[88:91], v[136:139]
    ds_read_b64_tr_b16 v[56:57], v236 offset:0
    v_mfma_f32_16x16x32_bf16 v[140:143], v[28:31], v[92:95], v[140:143]
    ds_read_b64_tr_b16 v[58:59], v236 offset:1024
    v_mfma_f32_16x16x32_bf16 v[144:147], v[32:35], v[88:91], v[144:147]
    ds_read_b64_tr_b16 v[60:61], v237 offset:0
    v_mfma_f32_16x16x32_bf16 v[148:151], v[32:35], v[92:95], v[148:151]
    ds_read_b64_tr_b16 v[62:63], v237 offset:1024
    s_add_u32 s58, s56, 24576
    v_mfma_f32_16x16x32_bf16 v[152:155], v[36:39], v[88:91], v[152:155]
    ds_read_b64_tr_b16 v[64:65], v238 offset:0
    s_mov_b32 m0, s58
    v_mfma_f32_16x16x32_bf16 v[156:159], v[36:39], v[92:95], v[156:159]
    ds_read_b64_tr_b16 v[66:67], v238 offset:1024
    s_add_u32 s59, s24, 832
    v_mfma_f32_16x16x32_bf16 v[160:163], v[40:43], v[88:91], v[160:163]
    ds_read_b64_tr_b16 v[68:69], v239 offset:0
    buffer_load_dwordx4 v2, s[12:15], s25 offen offset:0 lds
    v_mfma_f32_16x16x32_bf16 v[164:167], v[40:43], v[92:95], v[164:167]
    ds_read_b64_tr_b16 v[70:71], v239 offset:1024
    buffer_load_dwordx4 v3, s[12:15], s25 offen offset:1024 lds
    v_mfma_f32_16x16x32_bf16 v[168:171], v[44:47], v[88:91], v[168:171]
    ds_read_b64_tr_b16 v[72:73], v240 offset:0
    s_add_u32 s58, s57, 24576
    v_mfma_f32_16x16x32_bf16 v[172:175], v[44:47], v[92:95], v[172:175]
    ds_read_b64_tr_b16 v[74:75], v240 offset:1024
    s_mov_b32 m0, s58
    v_mfma_f32_16x16x32_bf16 v[200:203], v[216:219], v[88:91], v[200:203]
    ds_read_b64_tr_b16 v[76:77], v241 offset:0
    s_add_u32 s25, s25, s26
    v_mfma_f32_16x16x32_bf16 v[204:207], v[88:91], v[88:91], v[204:207]
    ds_read_b64_tr_b16 v[78:79], v241 offset:1024
    buffer_load_dwordx4 v4, s[8:11], s59 offen lds
    v_mfma_f32_16x16x32_bf16 v[208:211], v[24:27], v[216:219], v[208:211]
    v_mfma_f32_16x16x32_bf16 v[212:215], v[28:31], v[216:219], v[212:215]
    s_waitcnt vmcnt(9) lgkmcnt(0)
    s_barrier
    s_cmp_lt_u32 s27, 7
    s_cbranch_scc1 L_k1_t9
    v_mfma_f32_16x16x32_bf16 v[176:179], v[80:83], v[96:99], v[176:179]
    ds_read_b64_tr_b16 v[48:49], v242 offset:24576
    ds_read_b64_tr_b16 v[50:51], v242 offset:25600
    v_mfma_f32_16x16x32_bf16 v[180:183], v[80:83], v[100:103], v[180:183]
    s_cmp_lt_u32 s27, 8
    s_cbranch_scc1 L_k1_t9
    v_mfma_f32_16x16x32_bf16 v[184:187], v[84:87], v[96:99], v[184:187]
    ds_read_b64_tr_b16 v[52:53], v243 offset:24576
    ds_read_b64_tr_b16 v[54:55], v243 offset:25600
    v_mfma_f32_16x16x32_bf16 v[188:191], v[84:87], v[100:103], v[188:191]
L_k1_t9:
    v_mfma_f32_16x16x32_bf16 v[128:131], v[56:59], v[96:99], v[128:131]
    ds_read_b128 v[88:91], v244 offset:24576
    v_mfma_f32_16x16x32_bf16 v[132:135], v[56:59], v[100:103], v[132:135]
    ds_read_b128 v[92:95], v245 offset:24576
    v_mfma_f32_16x16x32_bf16 v[136:139], v[60:63], v[96:99], v[136:139]
    ds_read_b64_tr_b16 v[24:25], v236 offset:24576
    v_mfma_f32_16x16x32_bf16 v[140:143], v[60:63], v[100:103], v[140:143]
    ds_read_b64_tr_b16 v[26:27], v236 offset:25600
    v_mfma_f32_16x16x32_bf16 v[144:147], v[64:67], v[96:99], v[144:147]
    ds_read_b64_tr_b16 v[28:29], v237 offset:24576
    v_mfma_f32_16x16x32_bf16 v[148:151], v[64:67], v[100:103], v[148:151]
    ds_read_b64_tr_b16 v[30:31], v237 offset:25600
    s_add_u32 s58, s56, 49152
    v_mfma_f32_16x16x32_bf16 v[152:155], v[68:71], v[96:99], v[152:155]
    ds_read_b64_tr_b16 v[32:33], v238 offset:24576
    s_mov_b32 m0, s58
    v_mfma_f32_16x16x32_bf16 v[156:159], v[68:71], v[100:103], v[156:159]
    ds_read_b64_tr_b16 v[34:35], v238 offset:25600
    s_add_u32 s59, s24, 896
    v_mfma_f32_16x16x32_bf16 v[160:163], v[72:75], v[96:99], v[160:163]
    ds_read_b64_tr_b16 v[36:37], v239 offset:24576
    buffer_load_dwordx4 v2, s[12:15], s25 offen offset:0 lds
    v_mfma_f32_16x16x32_bf16 v[164:167], v[72:75], v[100:103], v[164:167]
    ds_read_b64_tr_b16 v[38:39], v239 offset:25600
    buffer_load_dwordx4 v3, s[12:15], s25 offen offset:1024 lds
    v_mfma_f32_16x16x32_bf16 v[168:171], v[76:79], v[96:99], v[168:171]
    ds_read_b64_tr_b16 v[40:41], v240 offset:24576
    s_add_u32 s58, s57, 49152
    v_mfma_f32_16x16x32_bf16 v[172:175], v[76:79], v[100:103], v[172:175]
    ds_read_b64_tr_b16 v[42:43], v240 offset:25600
    s_mov_b32 m0, s58
    v_mfma_f32_16x16x32_bf16 v[200:203], v[216:219], v[96:99], v[200:203]
    ds_read_b64_tr_b16 v[44:45], v241 offset:24576
    s_add_u32 s25, s25, s26
    v_mfma_f32_16x16x32_bf16 v[204:207], v[96:99], v[96:99], v[204:207]
    ds_read_b64_tr_b16 v[46:47], v241 offset:25600
    buffer_load_dwordx4 v4, s[8:11], s59 offen lds
    v_mfma_f32_16x16x32_bf16 v[208:211], v[56:59], v[216:219], v[208:211]
    v_mfma_f32_16x16x32_bf16 v[212:215], v[60:63], v[216:219], v[212:215]
    s_waitcnt vmcnt(9) lgkmcnt(0)
    s_barrier
    s_cmp_lt_u32 s27, 7
    s_cbranch_scc1 L_k1_t10
    v_mfma_f32_16x16x32_bf16 v[176:179], v[48:51], v[88:91], v[176:179]
    ds_read_b64_tr_b16 v[80:81], v242 offset:49152
    ds_read_b64_tr_b16 v[82:83], v242 offset:50176
    v_mfma_f32_16x16x32_bf16 v[180:183], v[48:51], v[92:95], v[180:183]
    s_cmp_lt_u32 s27, 8
    s_cbranch_scc1 L_k1_t10
    v_mfma_f32_16x16x32_bf16 v[184:187], v[52:55], v[88:91], v[184:187]
    ds_read_b64_tr_b16 v[84:85], v243 offset:49152
    ds_read_b64_tr_b16 v[86:87], v243 offset:50176
    v_mfma_f32_16x16x32_bf16 v[188:191], v[52:55], v[92:95], v[188:191]
L_k1_t10:
    v_mfma_f32_16x16x32_bf16 v[128:131], v[24:27], v[88:91], v[128:131]
    ds_read_b128 v[96:99], v244 offset:49152
    v_mfma_f32_16x16x32_bf16 v[132:135], v[24:27], v[92:95], v[132:135]
    ds_read_b128 v[100:103], v245 offset:49152
    v_mfma_f32_16x16x32_bf16 v[136:139], v[28:31], v[88:91], v[136:139]
    ds_read_b64_tr_b16 v[56:57], v236 offset:49152
    v_mfma_f32_16x16x32_bf16 v[140:143], v[28:31], v[92:95], v[140:143]
    ds_read_b64_tr_b16 v[58:59], v236 offset:50176
    v_mfma_f32_16x16x32_bf16 v[144:147], v[32:35], v[88:91], v[144:147]
    ds_read_b64_tr_b16 v[60:61], v237 offset:49152
    v_mfma_f32_16x16x32_bf16 v[148:151], v[32:35], v[92:95], v[148:151]
    ds_read_b64_tr_b16 v[62:63], v237 offset:50176
    s_add_u32 s58, s56, 73728
    v_mfma_f32_16x16x32_bf16 v[152:155], v[36:39], v[88:91], v[152:155]
    ds_read_b64_tr_b16 v[64:65], v238 offset:49152
    s_mov_b32 m0, s58
    v_mfma_f32_16x16x32_bf16 v[156:159], v[36:39], v[92:95], v[156:159]
    ds_read_b64_tr_b16 v[66:67], v238 offset:50176
    s_add_u32 s59, s24, 960
    v_mfma_f32_16x16x32_bf16 v[160:163], v[40:43], v[88:91], v[160:163]
    ds_read_b64_tr_b16 v[68:69], v239 offset:49152
    buffer_load_dwordx4 v2, s[12:15], s25 offen offset:0 lds
    v_mfma_f32_16x16x32_bf16 v[164:167], v[40:43], v[92:95], v[164:167]
    ds_read_b64_tr_b16 v[70:71], v239 offset:50176
    buffer_load_dwordx4 v3, s[12:15], s25 offen offset:1024 lds
    v_mfma_f32_16x16x32_bf16 v[168:171], v[44:47], v[88:91], v[168:171]
    ds_read_b64_tr_b16 v[72:73], v240 offset:49152
    s_add_u32 s58, s57, 73728
    v_mfma_f32_16x16x32_bf16 v[172:175], v[44:47], v[92:95], v[172:175]
    ds_read_b64_tr_b16 v[74:75], v240 offset:50176
    s_mov_b32 m0, s58
    v_mfma_f32_16x16x32_bf16 v[200:203], v[216:219], v[88:91], v[200:203]
    ds_read_b64_tr_b16 v[76:77], v241 offset:49152
    s_add_u32 s25, s25, s26
    v_mfma_f32_16x16x32_bf16 v[204:207], v[88:91], v[88:91], v[204:207]
    ds_read_b64_tr_b16 v[78:79], v241 offset:50176
    buffer_load_dwordx4 v4, s[8:11], s59 offen lds
    v_mfma_f32_16x16x32_bf16 v[208:211], v[24:27], v[216:219], v[208:211]
    v_mfma_f32_16x16x32_bf16 v[212:215], v[28:31], v[216:219], v[212:215]
    s_waitcnt vmcnt(9) lgkmcnt(0)
    s_barrier
    s_cmp_lt_u32 s27, 7
    s_cbranch_scc1 L_k1_t11
    v_mfma_f32_16x16x32_bf16 v[176:179], v[80:83], v[96:99], v[176:179]
    ds_read_b64_tr_b16 v[48:49], v12 offset:0
    ds_read_b64_tr_b16 v[50:51], v12 offset:1024
    v_mfma_f32_16x16x32_bf16 v[180:183], v[80:83], v[100:103], v[180:183]
    s_cmp_lt_u32 s27, 8
    s_cbranch_scc1 L_k1_t11
    v_mfma_f32_16x16x32_bf16 v[184:187], v[84:87], v[96:99], v[184:187]
    ds_read_b64_tr_b16 v[52:53], v13 offset:0
    ds_read_b64_tr_b16 v[54:55], v13 offset:1024
    v_mfma_f32_16x16x32_bf16 v[188:191], v[84:87], v[100:103], v[188:191]
L_k1_t11:
    v_mfma_f32_16x16x32_bf16 v[128:131], v[56:59], v[96:99], v[128:131]
    ds_read_b128 v[88:91], v14 offset:0
    v_mfma_f32_16x16x32_bf16 v[132:135], v[56:59], v[100:103], v[132:135]
    ds_read_b128 v[92:95], v15 offset:0
    v_mfma_f32_16x16x32_bf16 v[136:139], v[60:63], v[96:99], v[136:139]
    ds_read_b64_tr_b16 v[24:25], v6 offset:0
    v_mfma_f32_16x16x32_bf16 v[140:143], v[60:63], v[100:103], v[140:143]
    ds_read_b64_tr_b16 v[26:27], v6 offset:1024
    v_mfma_f32_16x16x32_bf16 v[144:147], v[64:67], v[96:99], v[144:147]
    ds_read_b64_tr_b16 v[28:29], v7 offset:0
    v_mfma_f32_16x16x32_bf16 v[148:151], v[64:67], v[100:103], v[148:151]
    ds_read_b64_tr_b16 v[30:31], v7 offset:1024
    s_add_u32 s58, s56, 98304
    v_mfma_f32_16x16x32_bf16 v[152:155], v[68:71], v[96:99], v[152:155]
    ds_read_b64_tr_b16 v[32:33], v8 offset:0
    s_mov_b32 m0, s58
    v_mfma_f32_16x16x32_bf16 v[156:159], v[68:71], v[100:103], v[156:159]
    ds_read_b64_tr_b16 v[34:35], v8 offset:1024
    s_add_u32 s59, s24, 1024
    v_mfma_f32_16x16x32_bf16 v[160:163], v[72:75], v[96:99], v[160:163]
    ds_read_b64_tr_b16 v[36:37], v9 offset:0
    buffer_load_dwordx4 v2, s[12:15], s25 offen offset:0 lds
    v_mfma_f32_16x16x32_bf16 v[164:167], v[72:75], v[100:103], v[164:167]
    ds_read_b64_tr_b16 v[38:39], v9 offset:1024
    buffer_load_dwordx4 v3, s[12:15], s25 offen offset:1024 lds
    v_mfma_f32_16x16x32_bf16 v[168:171], v[76:79], v[96:99], v[168:171]
    ds_read_b64_tr_b16 v[40:41], v10 offset:0
    s_add_u32 s58, s57, 98304
    v_mfma_f32_16x16x32_bf16 v[172:175], v[76:79], v[100:103], v[172:175]
    ds_read_b64_tr_b16 v[42:43], v10 offset:1024
    s_mov_b32 m0, s58
    v_mfma_f32_16x16x32_bf16 v[200:203], v[216:219], v[96:99], v[200:203]
    ds_read_b64_tr_b16 v[44:45], v11 offset:0
    s_add_u32 s25, s25, s26
    v_mfma_f32_16x16x32_bf16 v[204:207], v[96:99], v[96:99], v[204:207]
    ds_read_b64_tr_b16 v[46:47], v11 offset:1024
    buffer_load_dwordx4 v4, s[8:11], s59 offen lds
    v_mfma_f32_16x16x32_bf16 v[208:211], v[56:59], v[216:219], v[208:211]
    v_mfma_f32_16x16x32_bf16 v[212:215], v[60:63], v[216:219], v[212:215]
    s_waitcnt vmcnt(9) lgkmcnt(0)
    s_barrier
    s_cmp_lt_u32 s27, 7
    s_cbranch_scc1 L_k1_t12
    v_mfma_f32_16x16x32_bf16 v[176:179], v[48:51], v[88:91], v[176:179]
    ds_read_b64_tr_b16 v[80:81], v12 offset:24576
    ds_read_b64_tr_b16 v[82:83], v12 offset:25600
    v_mfma_f32_16x16x32_bf16 v[180:183], v[48:51], v[92:95], v[180:183]
    s_cmp_lt_u32 s27, 8
    s_cbranch_scc1 L_k1_t12
    v_mfma_f32_16x16x32_bf16 v[184:187], v[52:55], v[88:91], v[184:187]
    ds_read_b64_tr_b16 v[84:85], v13 offset:24576
    ds_read_b64_tr_b16 v[86:87], v13 offset:25600
    v_mfma_f32_16x16x32_bf16 v[188:191], v[52:55], v[92:95], v[188:191]
L_k1_t12:
    v_mfma_f32_16x16x32_bf16 v[128:131], v[24:27], v[88:91], v[128:131]
    ds_read_b128 v[96:99], v14 offset:24576
    v_mfma_f32_16x16x32_bf16 v[132:135], v[24:27], v[92:95], v[132:135]
    ds_read_b128 v[100:103], v15 offset:24576
    v_mfma_f32_16x16x32_bf16 v[136:139], v[28:31], v[88:91], v[136:139]
    ds_read_b64_tr_b16 v[56:57], v6 offset:24576
    v_mfma_f32_16x16x32_bf16 v[140:143], v[28:31], v[92:95], v[140:143]
    ds_read_b64_tr_b16 v[58:59], v6 offset:25600
    v_mfma_f32_16x16x32_bf16 v[144:147], v[32:35], v[88:91], v[144:147]
    ds_read_b64_tr_b16 v[60:61], v7 offset:24576
    v_mfma_f32_16x16x32_bf16 v[148:151], v[32:35], v[92:95], v[148:151]
    ds_read_b64_tr_b16 v[62:63], v7 offset:25600
    s_add_u32 s58, s56, 122880
    v_mfma_f32_16x16x32_bf16 v[152:155], v[36:39], v[88:91], v[152:155]
    ds_read_b64_tr_b16 v[64:65], v8 offset:24576
    s_mov_b32 m0, s58
    v_mfma_f32_16x16x32_bf16 v[156:159], v[36:39], v[92:95], v[156:159]
    ds_read_b64_tr_b16 v[66:67], v8 offset:25600
    s_add_u32 s59, s24, 1088
    v_mfma_f32_16x16x32_bf16 v[160:163], v[40:43], v[88:91], v[160:163]
    ds_read_b64_tr_b16 v[68:69], v9 offset:24576
    buffer_load_dwordx4 v2, s[12:15], s25 offen offset:0 lds
    v_mfma_f32_16x16x32_bf16 v[164:167], v[40:43], v[92:95], v[164:167]
    ds_read_b64_tr_b16 v[70:71], v9 offset:25600
    buffer_load_dwordx4 v3, s[12:15], s25 offen offset:1024 lds
    v_mfma_f32_16x16x32_bf16 v[168:171], v[44:47], v[88:91], v[168:171]
    ds_read_b64_tr_b16 v[72:73], v10 offset:24576
    s_add_u32 s58, s57, 122880
    v_mfma_f32_16x16x32_bf16 v[172:175], v[44:47], v[92:95], v[172:175]
    ds_read_b64_tr_b16 v[74:75], v10 offset:25600
    s_mov_b32 m0, s58
    v_mfma_f32_16x16x32_bf16 v[200:203], v[216:219], v[88:91], v[200:203]
    ds_read_b64_tr_b16 v[76:77], v11 offset:24576
    s_add_u32 s25, s25, s26
    v_mfma_f32_16x16x32_bf16 v[204:207], v[88:91], v[88:91], v[204:207]
    ds_read_b64_tr_b16 v[78:79], v11 offset:25600
    buffer_load_dwordx4 v4, s[8:11], s59 offen lds
    v_mfma_f32_16x16x32_bf16 v[208:211], v[24:27], v[216:219], v[208:211]
    v_mfma_f32_16x16x32_bf16 v[212:215], v[28:31], v[216:219], v[212:215]
    s_waitcnt vmcnt(9) lgkmcnt(0)
    s_barrier
    s_cmp_lt_u32 s27, 7
    s_cbranch_scc1 L_k1_t13
    v_mfma_f32_16x16x32_bf16 v[176:179], v[80:83], v[96:99], v[176:179]
    ds_read_b64_tr_b16 v[48:49], v12 offset:49152
    ds_read_b64_tr_b16 v[50:51], v12 offset:50176
    v_mfma_f32_16x16x32_bf16 v[180:183], v[80:83], v[100:103], v[180:183]
    s_cmp_lt_u32 s27, 8
    s_cbranch_scc1 L_k1_t13
    v_mfma_f32_16x16x32_bf16 v[184:187], v[84:87], v[96:99], v[184:187]
    ds_read_b64_tr_b16 v[52:53], v13 offset:49152
    ds_read_b64_tr_b16 v[54:55], v13 offset:50176
    v_mfma_f32_16x16x32_bf16 v[188:191], v[84:87], v[100:103], v[188:191]
L_k1_t13:
    v_mfma_f32_16x16x32_bf16 v[128:131], v[56:59], v[96:99], v[128:131]
    ds_read_b128 v[88:91], v14 offset:49152
    v_mfma_f32_16x16x32_bf16 v[132:135], v[56:59], v[100:103], v[132:135]
    ds_read_b128 v[92:95], v15 offset:49152
    v_mfma_f32_16x16x32_bf16 v[136:139], v[60:63], v[96:99], v[136:139]
    ds_read_b64_tr_b16 v[24:25], v6 offset:49152
    v_mfma_f32_16x16x32_bf16 v[140:143], v[60:63], v[100:103], v[140:143]
    ds_read_b64_tr_b16 v[26:27], v6 offset:50176
    v_mfma_f32_16x16x32_bf16 v[144:147], v[64:67], v[96:99], v[144:147]
    ds_read_b64_tr_b16 v[28:29], v7 offset:49152
    v_mfma_f32_16x16x32_bf16 v[148:151], v[64:67], v[100:103], v[148:151]
    ds_read_b64_tr_b16 v[30:31], v7 offset:50176
    s_add_u32 s58, s56, 0
    v_mfma_f32_16x16x32_bf16 v[152:155], v[68:71], v[96:99], v[152:155]
    ds_read_b64_tr_b16 v[32:33], v8 offset:49152
    s_mov_b32 m0, s58
    v_mfma_f32_16x16x32_bf16 v[156:159], v[68:71], v[100:103], v[156:159]
    ds_read_b64_tr_b16 v[34:35], v8 offset:50176
    s_add_u32 s59, s24, 1152
    v_mfma_f32_16x16x32_bf16 v[160:163], v[72:75], v[96:99], v[160:163]
    ds_read_b64_tr_b16 v[36:37], v9 offset:49152
    buffer_load_dwordx4 v2, s[12:15], s25 offen offset:0 lds
    v_mfma_f32_16x16x32_bf16 v[164:167], v[72:75], v[100:103], v[164:167]
    ds_read_b64_tr_b16 v[38:39], v9 offset:50176
    buffer_load_dwordx4 v3, s[12:15], s25 offen offset:1024 lds
    v_mfma_f32_16x16x32_bf16 v[168:171], v[76:79], v[96:99], v[168:171]
    ds_read_b64_tr_b16 v[40:41], v10 offset:49152
    s_add_u32 s58, s57, 0
    v_mfma_f32_16x16x32_bf16 v[172:175], v[76:79], v[100:103], v[172:175]
    ds_read_b64_tr_b16 v[42:43], v10 offset:50176
    s_mov_b32 m0, s58
    v_mfma_f32_16x16x32_bf16 v[200:203], v[216:219], v[96:99], v[200:203]
    ds_read_b64_tr_b16 v[44:45], v11 offset:49152
    s_add_u32 s25, s25, s26
    v_mfma_f32_16x16x32_bf16 v[204:207], v[96:99], v[96:99], v[204:207]
    ds_read_b64_tr_b16 v[46:47], v11 offset:50176
    buffer_load_dwordx4 v4, s[8:11], s59 offen lds
    v_mfma_f32_16x16x32_bf16 v[208:211], v[56:59], v[216:219], v[208:211]
    v_mfma_f32_16x16x32_bf16 v[212:215], v[60:63], v[216:219], v[212:215]
    s_waitcnt vmcnt(9) lgkmcnt(0)
    s_barrier
    s_cmp_lt_u32 s27, 7
    s_cbranch_scc1 L_k1_t14
    v_mfma_f32_16x16x32_bf16 v[176:179], v[48:51], v[88:91], v[176:179]
    ds_read_b64_tr_b16 v[80:81], v242 offset:0
    ds_read_b64_tr_b16 v[82:83], v242 offset:1024
    v_mfma_f32_16x16x32_bf16 v[180:183], v[48:51], v[92:95], v[180:183]
    s_cmp_lt_u32 s27, 8
    s_cbranch_scc1 L_k1_t14
    v_mfma_f32_16x16x32_bf16 v[184:187], v[52:55], v[88:91], v[184:187]
    ds_read_b64_tr_b16 v[84:85], v243 offset:0
    ds_read_b64_tr_b16 v[86:87], v243 offset:1024
    v_mfma_f32_16x16x32_bf16 v[188:191], v[52:55], v[92:95], v[188:191]
L_k1_t14:
    v_mfma_f32_16x16x32_bf16 v[128:131], v[24:27], v[88:91], v[128:131]
    ds_read_b128 v[96:99], v244 offset:0
    v_mfma_f32_16x16x32_bf16 v[132:135], v[24:27], v[92:95], v[132:135]
    ds_read_b128 v[100:103], v245 offset:0
    v_mfma_f32_16x16x32_bf16 v[136:139], v[28:31], v[88:91], v[136:139]
    ds_read_b64_tr_b16 v[56:57], v236 offset:0
    v_mfma_f32_16x16x32_bf16 v[140:143], v[28:31], v[92:95], v[140:143]
    ds_read_b64_tr_b16 v[58:59], v236 offset:1024
    v_mfma_f32_16x16x32_bf16 v[144:147], v[32:35], v[88:91], v[144:147]
    ds_read_b64_tr_b16 v[60:61], v237 offset:0
    v_mfma_f32_16x16x32_bf16 v[148:151], v[32:35], v[92:95], v[148:151]
    ds_read_b64_tr_b16 v[62:63], v237 offset:1024
    s_add_u32 s58, s56, 24576
    v_mfma_f32_16x16x32_bf16 v[152:155], v[36:39], v[88:91], v[152:155]
    ds_read_b64_tr_b16 v[64:65], v238 offset:0
    s_mov_b32 m0, s58
    v_mfma_f32_16x16x32_bf16 v[156:159], v[36:39], v[92:95], v[156:159]
    ds_read_b64_tr_b16 v[66:67], v238 offset:1024
    s_add_u32 s59, s24, 1216
    v_mfma_f32_16x16x32_bf16 v[160:163], v[40:43], v[88:91], v[160:163]
    ds_read_b64_tr_b16 v[68:69], v239 offset:0
    buffer_load_dwordx4 v2, s[12:15], s25 offen offset:0 lds
    v_mfma_f32_16x16x32_bf16 v[164:167], v[40:43], v[92:95], v[164:167]
    ds_read_b64_tr_b16 v[70:71], v239 offset:1024
    buffer_load_dwordx4 v3, s[12:15], s25 offen offset:1024 lds
    v_mfma_f32_16x16x32_bf16 v[168:171], v[44:47], v[88:91], v[168:171]
    ds_read_b64_tr_b16 v[72:73], v240 offset:0
    s_add_u32 s58, s57, 24576
    v_mfma_f32_16x16x32_bf16 v[172:175], v[44:47], v[92:95], v[172:175]
    ds_read_b64_tr_b16 v[74:75], v240 offset:1024
    s_mov_b32 m0, s58
    v_mfma_f32_16x16x32_bf16 v[200:203], v[216:219], v[88:91], v[200:203]
    ds_read_b64_tr_b16 v[76:77], v241 offset:0
    s_add_u32 s25, s25, s26
    v_mfma_f32_16x16x32_bf16 v[204:207], v[88:91], v[88:91], v[204:207]
    ds_read_b64_tr_b16 v[78:79], v241 offset:1024
    buffer_load_dwordx4 v4, s[8:11], s59 offen lds
    v_mfma_f32_16x16x32_bf16 v[208:211], v[24:27], v[216:219], v[208:211]
    v_mfma_f32_16x16x32_bf16 v[212:215], v[28:31], v[216:219], v[212:215]
    s_waitcnt vmcnt(9) lgkmcnt(0)
    s_barrier
    s_cmp_lt_u32 s27, 7
    s_cbranch_scc1 L_k1_t15
    v_mfma_f32_16x16x32_bf16 v[176:179], v[80:83], v[96:99], v[176:179]
    ds_read_b64_tr_b16 v[48:49], v242 offset:24576
    ds_read_b64_tr_b16 v[50:51], v242 offset:25600
    v_mfma_f32_16x16x32_bf16 v[180:183], v[80:83], v[100:103], v[180:183]
    s_cmp_lt_u32 s27, 8
    s_cbranch_scc1 L_k1_t15
    v_mfma_f32_16x16x32_bf16 v[184:187], v[84:87], v[96:99], v[184:187]
    ds_read_b64_tr_b16 v[52:53], v243 offset:24576
    ds_read_b64_tr_b16 v[54:55], v243 offset:25600
    v_mfma_f32_16x16x32_bf16 v[188:191], v[84:87], v[100:103], v[188:191]
L_k1_t15:
    v_mfma_f32_16x16x32_bf16 v[128:131], v[56:59], v[96:99], v[128:131]
    ds_read_b128 v[88:91], v244 offset:24576
    v_mfma_f32_16x16x32_bf16 v[132:135], v[56:59], v[100:103], v[132:135]
    ds_read_b128 v[92:95], v245 offset:24576
    v_mfma_f32_16x16x32_bf16 v[136:139], v[60:63], v[96:99], v[136:139]
    ds_read_b64_tr_b16 v[24:25], v236 offset:24576
    v_mfma_f32_16x16x32_bf16 v[140:143], v[60:63], v[100:103], v[140:143]
    ds_read_b64_tr_b16 v[26:27], v236 offset:25600
    v_mfma_f32_16x16x32_bf16 v[144:147], v[64:67], v[96:99], v[144:147]
    ds_read_b64_tr_b16 v[28:29], v237 offset:24576
    v_mfma_f32_16x16x32_bf16 v[148:151], v[64:67], v[100:103], v[148:151]
    ds_read_b64_tr_b16 v[30:31], v237 offset:25600
    v_mfma_f32_16x16x32_bf16 v[152:155], v[68:71], v[96:99], v[152:155]
    ds_read_b64_tr_b16 v[32:33], v238 offset:24576
    v_mfma_f32_16x16x32_bf16 v[156:159], v[68:71], v[100:103], v[156:159]
    ds_read_b64_tr_b16 v[34:35], v238 offset:25600
    v_mfma_f32_16x16x32_bf16 v[160:163], v[72:75], v[96:99], v[160:163]
    ds_read_b64_tr_b16 v[36:37], v239 offset:24576
    v_mfma_f32_16x16x32_bf16 v[164:167], v[72:75], v[100:103], v[164:167]
    ds_read_b64_tr_b16 v[38:39], v239 offset:25600
    v_mfma_f32_16x16x32_bf16 v[168:171], v[76:79], v[96:99], v[168:171]
    ds_read_b64_tr_b16 v[40:41], v240 offset:24576
    v_mfma_f32_16x16x32_bf16 v[172:175], v[76:79], v[100:103], v[172:175]
    ds_read_b64_tr_b16 v[42:43], v240 offset:25600
    v_mfma_f32_16x16x32_bf16 v[200:203], v[216:219], v[96:99], v[200:203]
    ds_read_b64_tr_b16 v[44:45], v241 offset:24576
    v_mfma_f32_16x16x32_bf16 v[204:207], v[96:99], v[96:99], v[204:207]
    ds_read_b64_tr_b16 v[46:47], v241 offset:25600
    v_mfma_f32_16x16x32_bf16 v[208:211], v[56:59], v[216:219], v[208:211]
    v_mfma_f32_16x16x32_bf16 v[212:215], v[60:63], v[216:219], v[212:215]
    s_waitcnt vmcnt(6) lgkmcnt(0)
    s_barrier
    s_cmp_lt_u32 s27, 7
    s_cbranch_scc1 L_k1_t16
    v_mfma_f32_16x16x32_bf16 v[176:179], v[48:51], v[88:91], v[176:179]
    ds_read_b64_tr_b16 v[80:81], v242 offset:49152
    ds_read_b64_tr_b16 v[82:83], v242 offset:50176
    v_mfma_f32_16x16x32_bf16 v[180:183], v[48:51], v[92:95], v[180:183]
    s_cmp_lt_u32 s27, 8
    s_cbranch_scc1 L_k1_t16
    v_mfma_f32_16x16x32_bf16 v[184:187], v[52:55], v[88:91], v[184:187]
    ds_read_b64_tr_b16 v[84:85], v243 offset:49152
    ds_read_b64_tr_b16 v[86:87], v243 offset:50176
    v_mfma_f32_16x16x32_bf16 v[188:191], v[52:55], v[92:95], v[188:191]
L_k1_t16:
    v_mfma_f32_16x16x32_bf16 v[128:131], v[24:27], v[88:91], v[128:131]
    ds_read_b128 v[96:99], v244 offset:49152
    v_mfma_f32_16x16x32_bf16 v[132:135], v[24:27], v[92:95], v[132:135]
    ds_read_b128 v[100:103], v245 offset:49152
    v_mfma_f32_16x16x32_bf16 v[136:139], v[28:31], v[88:91], v[136:139]
    ds_read_b64_tr_b16 v[56:57], v236 offset:49152
    v_mfma_f32_16x16x32_bf16 v[140:143], v[28:31], v[92:95], v[140:143]
    ds_read_b64_tr_b16 v[58:59], v236 offset:50176
    v_mfma_f32_16x16x32_bf16 v[144:147], v[32:35], v[88:91], v[144:147]
    ds_read_b64_tr_b16 v[60:61], v237 offset:49152
    v_mfma_f32_16x16x32_bf16 v[148:151], v[32:35], v[92:95], v[148:151]
    ds_read_b64_tr_b16 v[62:63], v237 offset:50176
    v_mfma_f32_16x16x32_bf16 v[152:155], v[36:39], v[88:91], v[152:155]
    ds_read_b64_tr_b16 v[64:65], v238 offset:49152
    v_mfma_f32_16x16x32_bf16 v[156:159], v[36:39], v[92:95], v[156:159]
    ds_read_b64_tr_b16 v[66:67], v238 offset:50176
    v_mfma_f32_16x16x32_bf16 v[160:163], v[40:43], v[88:91], v[160:163]
    ds_read_b64_tr_b16 v[68:69], v239 offset:49152
    v_mfma_f32_16x16x32_bf16 v[164:167], v[40:43], v[92:95], v[164:167]
    ds_read_b64_tr_b16 v[70:71], v239 offset:50176
    v_mfma_f32_16x16x32_bf16 v[168:171], v[44:47], v[88:91], v[168:171]
    ds_read_b64_tr_b16 v[72:73], v240 offset:49152
    v_mfma_f32_16x16x32_bf16 v[172:175], v[44:47], v[92:95], v[172:175]
    ds_read_b64_tr_b16 v[74:75], v240 offset:50176
    v_mfma_f32_16x16x32_bf16 v[200:203], v[216:219], v[88:91], v[200:203]
    ds_read_b64_tr_b16 v[76:77], v241 offset:49152
    v_mfma_f32_16x16x32_bf16 v[204:207], v[88:91], v[88:91], v[204:207]
    ds_read_b64_tr_b16 v[78:79], v241 offset:50176
    v_mfma_f32_16x16x32_bf16 v[208:211], v[24:27], v[216:219], v[208:211]
    v_mfma_f32_16x16x32_bf16 v[212:215], v[28:31], v[216:219], v[212:215]
    s_waitcnt vmcnt(3) lgkmcnt(0)
    s_barrier
    s_cmp_lt_u32 s27, 7
    s_cbranch_scc1 L_k1_t17
    v_mfma_f32_16x16x32_bf16 v[176:179], v[80:83], v[96:99], v[176:179]
    ds_read_b64_tr_b16 v[48:49], v12 offset:0
    ds_read_b64_tr_b16 v[50:51], v12 offset:1024
    v_mfma_f32_16x16x32_bf16 v[180:183], v[80:83], v[100:103], v[180:183]
    s_cmp_lt_u32 s27, 8
    s_cbranch_scc1 L_k1_t17
    v_mfma_f32_16x16x32_bf16 v[184:187], v[84:87], v[96:99], v[184:187]
    ds_read_b64_tr_b16 v[52:53], v13 offset:0
    ds_read_b64_tr_b16 v[54:55], v13 offset:1024
    v_mfma_f32_16x16x32_bf16 v[188:191], v[84:87], v[100:103], v[188:191]
L_k1_t17:
    v_mfma_f32_16x16x32_bf16 v[128:131], v[56:59], v[96:99], v[128:131]
    ds_read_b128 v[88:91], v14 offset:0
    v_mfma_f32_16x16x32_bf16 v[132:135], v[56:59], v[100:103], v[132:135]
    ds_read_b128 v[92:95], v15 offset:0
    v_mfma_f32_16x16x32_bf16 v[136:139], v[60:63], v[96:99], v[136:139]
    ds_read_b64_tr_b16 v[24:25], v6 offset:0
    v_mfma_f32_16x16x32_bf16 v[140:143], v[60:63], v[100:103], v[140:143]
    ds_read_b64_tr_b16 v[26:27], v6 offset:1024
    v_mfma_f32_16x16x32_bf16 v[144:147], v[64:67], v[96:99], v[144:147]
    ds_read_b64_tr_b16 v[28:29], v7 offset:0
    v_mfma_f32_16x16x32_bf16 v[148:151], v[64:67], v[100:103], v[148:151]
    ds_read_b64_tr_b16 v[30:31], v7 offset:1024
    v_mfma_f32_16x16x32_bf16 v[152:155], v[68:71], v[96:99], v[152:155]
    ds_read_b64_tr_b16 v[32:33], v8 offset:0
    v_mfma_f32_16x16x32_bf16 v[156:159], v[68:71], v[100:103], v[156:159]
    ds_read_b64_tr_b16 v[34:35], v8 offset:1024
    v_mfma_f32_16x16x32_bf16 v[160:163], v[72:75], v[96:99], v[160:163]
    ds_read_b64_tr_b16 v[36:37], v9 offset:0
    v_mfma_f32_16x16x32_bf16 v[164:167], v[72:75], v[100:103], v[164:167]
    ds_read_b64_tr_b16 v[38:39], v9 offset:1024
    v_mfma_f32_16x16x32_bf16 v[168:171], v[76:79], v[96:99], v[168:171]
    ds_read_b64_tr_b16 v[40:41], v10 offset:0
    v_mfma_f32_16x16x32_bf16 v[172:175], v[76:79], v[100:103], v[172:175]
    ds_read_b64_tr_b16 v[42:43], v10 offset:1024
    v_mfma_f32_16x16x32_bf16 v[200:203], v[216:219], v[96:99], v[200:203]
    ds_read_b64_tr_b16 v[44:45], v11 offset:0
    v_mfma_f32_16x16x32_bf16 v[204:207], v[96:99], v[96:99], v[204:207]
    ds_read_b64_tr_b16 v[46:47], v11 offset:1024
    v_mfma_f32_16x16x32_bf16 v[208:211], v[56:59], v[216:219], v[208:211]
    v_mfma_f32_16x16x32_bf16 v[212:215], v[60:63], v[216:219], v[212:215]
    s_waitcnt vmcnt(0) lgkmcnt(0)
    s_barrier
    s_cmp_lt_u32 s27, 7
    s_cbranch_scc1 L_k1_t18
    v_mfma_f32_16x16x32_bf16 v[176:179], v[48:51], v[88:91], v[176:179]
    ds_read_b64_tr_b16 v[80:81], v12 offset:24576
    ds_read_b64_tr_b16 v[82:83], v12 offset:25600
    v_mfma_f32_16x16x32_bf16 v[180:183], v[48:51], v[92:95], v[180:183]
    s_cmp_lt_u32 s27, 8
    s_cbranch_scc1 L_k1_t18
    v_mfma_f32_16x16x32_bf16 v[184:187], v[52:55], v[88:91], v[184:187]
    ds_read_b64_tr_b16 v[84:85], v13 offset:24576
    ds_read_b64_tr_b16 v[86:87], v13 offset:25600
    v_mfma_f32_16x16x32_bf16 v[188:191], v[52:55], v[92:95], v[188:191]
L_k1_t18:
    v_mfma_f32_16x16x32_bf16 v[128:131], v[24:27], v[88:91], v[128:131]
    ds_read_b128 v[96:99], v14 offset:24576
    v_mfma_f32_16x16x32_bf16 v[132:135], v[24:27], v[92:95], v[132:135]
    ds_read_b128 v[100:103], v15 offset:24576
    v_mfma_f32_16x16x32_bf16 v[136:139], v[28:31], v[88:91], v[136:139]
    ds_read_b64_tr_b16 v[56:57], v6 offset:24576
    v_mfma_f32_16x16x32_bf16 v[140:143], v[28:31], v[92:95], v[140:143]
    ds_read_b64_tr_b16 v[58:59], v6 offset:25600
    v_mfma_f32_16x16x32_bf16 v[144:147], v[32:35], v[88:91], v[144:147]
    ds_read_b64_tr_b16 v[60:61], v7 offset:24576
    v_mfma_f32_16x16x32_bf16 v[148:151], v[32:35], v[92:95], v[148:151]
    ds_read_b64_tr_b16 v[62:63], v7 offset:25600
    v_mfma_f32_16x16x32_bf16 v[152:155], v[36:39], v[88:91], v[152:155]
    ds_read_b64_tr_b16 v[64:65], v8 offset:24576
    v_mfma_f32_16x16x32_bf16 v[156:159], v[36:39], v[92:95], v[156:159]
    ds_read_b64_tr_b16 v[66:67], v8 offset:25600
    v_mfma_f32_16x16x32_bf16 v[160:163], v[40:43], v[88:91], v[160:163]
    ds_read_b64_tr_b16 v[68:69], v9 offset:24576
    v_mfma_f32_16x16x32_bf16 v[164:167], v[40:43], v[92:95], v[164:167]
    ds_read_b64_tr_b16 v[70:71], v9 offset:25600
    v_mfma_f32_16x16x32_bf16 v[168:171], v[44:47], v[88:91], v[168:171]
    ds_read_b64_tr_b16 v[72:73], v10 offset:24576
    v_mfma_f32_16x16x32_bf16 v[172:175], v[44:47], v[92:95], v[172:175]
    ds_read_b64_tr_b16 v[74:75], v10 offset:25600
    v_mfma_f32_16x16x32_bf16 v[200:203], v[216:219], v[88:91], v[200:203]
    ds_read_b64_tr_b16 v[76:77], v11 offset:24576
    v_mfma_f32_16x16x32_bf16 v[204:207], v[88:91], v[88:91], v[204:207]
    ds_read_b64_tr_b16 v[78:79], v11 offset:25600
    v_mfma_f32_16x16x32_bf16 v[208:211], v[24:27], v[216:219], v[208:211]
    v_mfma_f32_16x16x32_bf16 v[212:215], v[28:31], v[216:219], v[212:215]
    s_waitcnt lgkmcnt(0)
    s_cmp_lt_u32 s27, 7
    s_cbranch_scc1 L_k1_t19
    v_mfma_f32_16x16x32_bf16 v[176:179], v[80:83], v[96:99], v[176:179]
    v_mfma_f32_16x16x32_bf16 v[180:183], v[80:83], v[100:103], v[180:183]
    s_cmp_lt_u32 s27, 8
    s_cbranch_scc1 L_k1_t19
    v_mfma_f32_16x16x32_bf16 v[184:187], v[84:87], v[96:99], v[184:187]
    v_mfma_f32_16x16x32_bf16 v[188:191], v[84:87], v[100:103], v[188:191]
L_k1_t19:
    v_mfma_f32_16x16x32_bf16 v[128:131], v[56:59], v[96:99], v[128:131]
    v_mfma_f32_16x16x32_bf16 v[132:135], v[56:59], v[100:103], v[132:135]
    v_mfma_f32_16x16x32_bf16 v[136:139], v[60:63], v[96:99], v[136:139]
    v_mfma_f32_16x16x32_bf16 v[140:143], v[60:63], v[100:103], v[140:143]
    v_mfma_f32_16x16x32_bf16 v[144:147], v[64:67], v[96:99], v[144:147]
    v_mfma_f32_16x16x32_bf16 v[148:151], v[64:67], v[100:103], v[148:151]
    v_mfma_f32_16x16x32_bf16 v[152:155], v[68:71], v[96:99], v[152:155]
    v_mfma_f32_16x16x32_bf16 v[156:159], v[68:71], v[100:103], v[156:159]
    v_mfma_f32_16x16x32_bf16 v[160:163], v[72:75], v[96:99], v[160:163]
    v_mfma_f32_16x16x32_bf16 v[164:167], v[72:75], v[100:103], v[164:167]
    v_mfma_f32_16x16x32_bf16 v[168:171], v[76:79], v[96:99], v[168:171]
    v_mfma_f32_16x16x32_bf16 v[172:175], v[76:79], v[100:103], v[172:175]
    v_mfma_f32_16x16x32_bf16 v[200:203], v[216:219], v[96:99], v[200:203]
    v_mfma_f32_16x16x32_bf16 v[204:207], v[96:99], v[96:99], v[204:207]
    v_mfma_f32_16x16x32_bf16 v[208:211], v[56:59], v[216:219], v[208:211]
    v_mfma_f32_16x16x32_bf16 v[212:215], v[60:63], v[216:219], v[212:215]
    v_and_b32 v18, 15, v1
    v_lshrrev_b32 v19, 4, v1
    s_lshl_b32 s28, s17, 1
    s_add_u32 s28, s28, s18
    s_lshl_b32 s28, s28, 7
    s_add_u32 s28, s28, 147456
    v_lshl_add_u32 v192, v18, 3, s28
    v_and_b32 v193, 3, v1
    v_bfe_u32 v194, v1, 2, 2
    s_nop 7
    v_cmp_eq_u32 vcc, 1, v193
    s_nop 1
    v_cndmask_b32 v204, v204, v205, vcc
    v_cmp_eq_u32 vcc, 2, v193
    s_nop 1
    v_cndmask_b32 v204, v204, v206, vcc
    v_cmp_eq_u32 vcc, 3, v193
    s_nop 1
    v_cndmask_b32 v204, v204, v207, vcc
    ds_write_b32 v192, v200
    v_cmp_eq_u32 vcc, v194, v19
    s_and_saveexec_b64 s[28:29], vcc
    ds_write_b32 v192, v204 offset:4
    s_mov_b64 exec, s[28:29]
    s_lshl_b32 s28, s80, 6
    s_add_u32 s28, s28, 148480
    v_lshl_add_u32 v193, v19, 4, s28
    ds_write_b128 v193, v[208:211]
    s_lshl_b32 s28, s81, 6
    s_add_u32 s28, s28, 148480
    v_lshl_add_u32 v193, v19, 4, s28
    ds_write_b128 v193, v[212:215]
    s_waitcnt lgkmcnt(0)
    s_barrier
    s_add_u32 s28, s18, 0
    s_and_b32 s28, s28, 1
    s_lshl_b32 s29, s17, 1
    s_add_u32 s28, s28, s29
    s_lshl_b32 s28, s28, 7
    s_add_u32 s28, s28, 147456
    v_lshl_add_u32 v192, v18, 3, s28
    ds_read_b64 v[24:25], v192
    s_add_u32 s28, s18, 1
    s_and_b32 s28, s28, 1
    s_lshl_b32 s29, s17, 1
    s_add_u32 s28, s28, s29
    s_lshl_b32 s28, s28, 7
    s_add_u32 s28, s28, 147456
    v_lshl_add_u32 v192, v18, 3, s28
    ds_read_b64 v[26:27], v192
    s_lshl_b32 s28, s80, 6
    s_add_u32 s28, s28, 148480
    v_lshl_add_u32 v192, v19, 4, s28
    ds_read_b128 v[32:35], v192
    s_lshl_b32 s28, s81, 6
    s_add_u32 s28, s28, 148480
    v_lshl_add_u32 v192, v19, 4, s28
    ds_read_b128 v[36:39], v192
    s_lshl_b32 s28, s82, 6
    s_add_u32 s28, s28, 148480
    v_lshl_add_u32 v192, v19, 4, s28
    ds_read_b128 v[40:43], v192
    s_lshl_b32 s28, s83, 6
    s_add_u32 s28, s28, 148480
    v_lshl_add_u32 v192, v19, 4, s28
    ds_read_b128 v[44:47], v192
    s_lshl_b32 s28, s84, 6
    s_add_u32 s28, s28, 148480
    v_lshl_add_u32 v192, v19, 4, s28
    ds_read_b128 v[48:51], v192
    s_lshl_b32 s28, s85, 6
    s_add_u32 s28, s28, 148480
    v_lshl_add_u32 v192, v19, 4, s28
    ds_read_b128 v[52:55], v192
    s_lshl_b32 s28, s86, 6
    s_add_u32 s28, s28, 148480
    v_lshl_add_u32 v192, v19, 4, s28
    ds_read_b128 v[56:59], v192
    s_lshl_b32 s28, s87, 6
    s_add_u32 s28, s28, 148480
    v_lshl_add_u32 v192, v19, 4, s28
    ds_read_b128 v[60:63], v192
    s_waitcnt lgkmcnt(0)
    s_mov_b32 s28, 986500301
    s_mov_b32 s29, 925353388
    v_mul_f32 v24, s28, v24
    v_mul_f32 v25, s28, v25
    v_fma_f32 v25, -v24, v24, v25
    v_max_f32 v25, 0, v25
    v_mov_b32 v192, v24
    v_mov_b32 v193, v25
    v_cvt_pk_bf16_f32 v194, v24, v24
    v_lshlrev_b32 v24, 16, v194
    v_cvt_pk_bf16_f32 v194, v25, v25
    v_lshlrev_b32 v25, 16, v194
    v_add_f32 v25, s29, v25
    v_cvt_pk_bf16_f32 v194, v25, v25
    v_lshlrev_b32 v25, 16, v194
    v_sqrt_f32 v25, v25
    s_nop 0
    v_cvt_pk_bf16_f32 v194, v25, v25
    v_lshlrev_b32 v25, 16, v194
    v_mov_b32 v195, v25
    v_rcp_f32 v25, v25
    s_cmp_eq_u32 s23, 0
    s_cbranch_scc1 L_k1_rp0
    v_sub_f32 v192, v192, v24
    v_mul_f32 v192, v192, v25
    v_mul_f32 v193, v193, v25
    v_mul_f32 v193, v193, v25
    v_cvt_pk_bf16_f32 v194, v192, v192
    v_lshlrev_b32 v192, 16, v194
    v_cvt_pk_bf16_f32 v194, v193, v193
    v_lshlrev_b32 v193, 16, v194
    v_add_f32 v193, s29, v193
    v_cvt_pk_bf16_f32 v194, v193, v193
    v_lshlrev_b32 v193, 16, v194
    v_sqrt_f32 v193, v193
    s_nop 0
    v_cvt_pk_bf16_f32 v194, v193, v193
    v_lshlrev_b32 v193, 16, v194
    v_rcp_f32 v193, v193
    v_fma_f32 v24, v192, v195, v24
    v_mul_f32 v25, v25, v193
L_k1_rp0:
    v_mul_f32 v26, s28, v26
    v_mul_f32 v27, s28, v27
    v_fma_f32 v27, -v26, v26, v27
    v_max_f32 v27, 0, v27
    v_mov_b32 v192, v26
    v_mov_b32 v193, v27
    v_cvt_pk_bf16_f32 v194, v26, v26
    v_lshlrev_b32 v26, 16, v194
    v_cvt_pk_bf16_f32 v194, v27, v27
    v_lshlrev_b32 v27, 16, v194
    v_add_f32 v27, s29, v27
    v_cvt_pk_bf16_f32 v194, v27, v27
    v_lshlrev_b32 v27, 16, v194
    v_sqrt_f32 v27, v27
    s_nop 0
    v_cvt_pk_bf16_f32 v194, v27, v27
    v_lshlrev_b32 v27, 16, v194
    v_mov_b32 v195, v27
    v_rcp_f32 v27, v27
    s_cmp_eq_u32 s23, 0
    s_cbranch_scc1 L_k1_rp1
    v_sub_f32 v192, v192, v26
    v_mul_f32 v192, v192, v27
    v_mul_f32 v193, v193, v27
    v_mul_f32 v193, v193, v27
    v_cvt_pk_bf16_f32 v194, v192, v192
    v_lshlrev_b32 v192, 16, v194
    v_cvt_pk_bf16_f32 v194, v193, v193
    v_lshlrev_b32 v193, 16, v194
    v_add_f32 v193, s29, v193
    v_cvt_pk_bf16_f32 v194, v193, v193
    v_lshlrev_b32 v193, 16, v194
    v_sqrt_f32 v193, v193
    s_nop 0
    v_cvt_pk_bf16_f32 v194, v193, v193
    v_lshlrev_b32 v193, 16, v194
    v_rcp_f32 v193, v193
    v_fma_f32 v26, v192, v195, v26
    v_mul_f32 v27, v27, v193
L_k1_rp1:
    s_cmp_lg_u32 s23, 0
    s_cbranch_scc1 L_k1_mlp
    s_add_u32 s28, s18, 0
    s_and_b32 s28, s28, 1
    s_lshl_b32 s29, s17, 1
    s_add_u32 s28, s28, s29
    s_lshl_b32 s29, s19, 3
    s_add_u32 s28, s28, s29
    s_lshr_b32 s29, s28, 1
    s_mul_i32 s29, s29, 1536
    v_mov_b32 v64, s29
    s_and_b32 s28, s28, 1
    s_lshl_b32 s28, s28, 4
    v_add_u32 v68, s28, v18
    s_add_u32 s28, s18, 1
    s_and_b32 s28, s28, 1
    s_lshl_b32 s29, s17, 1
    s_add_u32 s28, s28, s29
    s_lshl_b32 s29, s19, 3
    s_add_u32 s28, s28, s29
    s_lshr_b32 s29, s28, 1
    s_mul_i32 s29, s29, 1536
    v_mov_b32 v65, s29
    s_and_b32 s28, s28, 1
    s_lshl_b32 s28, s28, 4
    v_add_u32 v69, s28, v18
    s_lshl_b32 s28, s80, 4
    s_add_u32 s28, s28, s21
    s_cmp_lt_u32 s28, 640
    s_cselect_b32 s29, 1051011932, 1.0
    s_lshr_b32 s28, s28, 2
    v_add_u32 v192, s28, v19
    v_mul_u32_u24 v193, 0xcccd, v192
    v_lshrrev_b32 v193, 18, v193
    v_mul_u32_u24 v194, 5, v193
    v_sub_u32 v192, v192, v194
    v_cmp_lt_u32 vcc, 63, v193
    v_mul_u32_u24 v193, 98304, v193
    v_lshlrev_b32 v195, 2, v192
    v_cndmask_b32 v195, 0, v195, vcc
    v_lshl_add_u32 v192, v192, 8, v193
    v_mul_f32 v72, s29, v25
    v_mul_f32 v74, s29, v27
    v_pk_fma_f32 v[128:129], v[24:25], v[32:33], v[128:129] op_sel_hi:[0,1,1] neg_lo:[1,0,0] neg_hi:[1,0,0]
    v_pk_fma_f32 v[130:131], v[24:25], v[34:35], v[130:131] op_sel_hi:[0,1,1] neg_lo:[1,0,0] neg_hi:[1,0,0]
    v_pk_mul_f32 v[128:129], v[72:73], v[128:129] op_sel_hi:[0,1]
    v_pk_mul_f32 v[130:131], v[72:73], v[130:131] op_sel_hi:[0,1]
    v_add_u32 v104, v195, v68
    v_cvt_pk_bf16_f32 v128, v128, v129
    v_and_b32 v104, 31, v104
    v_cvt_pk_bf16_f32 v129, v130, v131
    v_lshl_add_u32 v104, v104, 3, v192
    v_add_u32 v130, v104, v64
    buffer_store_dwordx2 v[128:129], v130, s[44:47], 0 offen
    v_pk_fma_f32 v[132:133], v[26:27], v[32:33], v[132:133] op_sel_hi:[0,1,1] neg_lo:[1,0,0] neg_hi:[1,0,0]
    v_pk_fma_f32 v[134:135], v[26:27], v[34:35], v[134:135] op_sel_hi:[0,1,1] neg_lo:[1,0,0] neg_hi:[1,0,0]
    v_pk_mul_f32 v[132:133], v[74:75], v[132:133] op_sel_hi:[0,1]
    v_pk_mul_f32 v[134:135], v[74:75], v[134:135] op_sel_hi:[0,1]
    v_add_u32 v105, v195, v69
    v_cvt_pk_bf16_f32 v132, v132, v133
    v_and_b32 v105, 31, v105
    v_cvt_pk_bf16_f32 v133, v134, v135
    v_lshl_add_u32 v105, v105, 3, v192
    v_add_u32 v134, v105, v65
    buffer_store_dwordx2 v[132:133], v134, s[44:47], 0 offen
    s_lshl_b32 s28, s81, 4
    s_add_u32 s28, s28, s21
    s_cmp_lt_u32 s28, 640
    s_cselect_b32 s29, 1051011932, 1.0
    s_lshr_b32 s28, s28, 2
    v_add_u32 v192, s28, v19
    v_mul_u32_u24 v193, 0xcccd, v192
    v_lshrrev_b32 v193, 18, v193
    v_mul_u32_u24 v194, 5, v193
    v_sub_u32 v192, v192, v194
    v_cmp_lt_u32 vcc, 63, v193
    v_mul_u32_u24 v193, 98304, v193
    v_lshlrev_b32 v195, 2, v192
    v_cndmask_b32 v195, 0, v195, vcc
    v_lshl_add_u32 v192, v192, 8, v193
    v_mul_f32 v72, s29, v25
    v_mul_f32 v74, s29, v27
    v_pk_fma_f32 v[136:137], v[24:25], v[36:37], v[136:137] op_sel_hi:[0,1,1] neg_lo:[1,0,0] neg_hi:[1,0,0]
    v_pk_fma_f32 v[138:139], v[24:25], v[38:39], v[138:139] op_sel_hi:[0,1,1] neg_lo:[1,0,0] neg_hi:[1,0,0]
    v_pk_mul_f32 v[136:137], v[72:73], v[136:137] op_sel_hi:[0,1]
    v_pk_mul_f32 v[138:139], v[72:73], v[138:139] op_sel_hi:[0,1]
    v_add_u32 v104, v195, v68
    v_cvt_pk_bf16_f32 v136, v136, v137
    v_and_b32 v104, 31, v104
    v_cvt_pk_bf16_f32 v137, v138, v139
    v_lshl_add_u32 v104, v104, 3, v192
    v_add_u32 v138, v104, v64
    buffer_store_dwordx2 v[136:137], v138, s[44:47], 0 offen
    v_pk_fma_f32 v[140:141], v[26:27], v[36:37], v[140:141] op_sel_hi:[0,1,1] neg_lo:[1,0,0] neg_hi:[1,0,0]
    v_pk_fma_f32 v[142:143], v[26:27], v[38:39], v[142:143] op_sel_hi:[0,1,1] neg_lo:[1,0,0] neg_hi:[1,0,0]
    v_pk_mul_f32 v[140:141], v[74:75], v[140:141] op_sel_hi:[0,1]
    v_pk_mul_f32 v[142:143], v[74:75], v[142:143] op_sel_hi:[0,1]
    v_add_u32 v105, v195, v69
    v_cvt_pk_bf16_f32 v140, v140, v141
    v_and_b32 v105, 31, v105
    v_cvt_pk_bf16_f32 v141, v142, v143
    v_lshl_add_u32 v105, v105, 3, v192
    v_add_u32 v142, v105, v65
    buffer_store_dwordx2 v[140:141], v142, s[44:47], 0 offen
    s_lshl_b32 s28, s82, 4
    s_add_u32 s28, s28, s21
    s_cmp_lt_u32 s28, 640
    s_cselect_b32 s29, 1051011932, 1.0
    s_lshr_b32 s28, s28, 2
    v_add_u32 v192, s28, v19
    v_mul_u32_u24 v193, 0xcccd, v192
    v_lshrrev_b32 v193, 18, v193
    v_mul_u32_u24 v194, 5, v193
    v_sub_u32 v192, v192, v194
    v_cmp_lt_u32 vcc, 63, v193
    v_mul_u32_u24 v193, 98304, v193
    v_lshlrev_b32 v195, 2, v192
    v_cndmask_b32 v195, 0, v195, vcc
    v_lshl_add_u32 v192, v192, 8, v193
    v_mul_f32 v72, s29, v25
    v_mul_f32 v74, s29, v27
    v_pk_fma_f32 v[144:145], v[24:25], v[40:41], v[144:145] op_sel_hi:[0,1,1] neg_lo:[1,0,0] neg_hi:[1,0,0]
    v_pk_fma_f32 v[146:147], v[24:25], v[42:43], v[146:147] op_sel_hi:[0,1,1] neg_lo:[1,0,0] neg_hi:[1,0,0]
    v_pk_mul_f32 v[144:145], v[72:73], v[144:145] op_sel_hi:[0,1]
    v_pk_mul_f32 v[146:147], v[72:73], v[146:147] op_sel_hi:[0,1]
    v_add_u32 v104, v195, v68
    v_cvt_pk_bf16_f32 v144, v144, v145
    v_and_b32 v104, 31, v104
    v_cvt_pk_bf16_f32 v145, v146, v147
    v_lshl_add_u32 v104, v104, 3, v192
    v_add_u32 v146, v104, v64
    buffer_store_dwordx2 v[144:145], v146, s[44:47], 0 offen
    v_pk_fma_f32 v[148:149], v[26:27], v[40:41], v[148:149] op_sel_hi:[0,1,1] neg_lo:[1,0,0] neg_hi:[1,0,0]
    v_pk_fma_f32 v[150:151], v[26:27], v[42:43], v[150:151] op_sel_hi:[0,1,1] neg_lo:[1,0,0] neg_hi:[1,0,0]
    v_pk_mul_f32 v[148:149], v[74:75], v[148:149] op_sel_hi:[0,1]
    v_pk_mul_f32 v[150:151], v[74:75], v[150:151] op_sel_hi:[0,1]
    v_add_u32 v105, v195, v69
    v_cvt_pk_bf16_f32 v148, v148, v149
    v_and_b32 v105, 31, v105
    v_cvt_pk_bf16_f32 v149, v150, v151
    v_lshl_add_u32 v105, v105, 3, v192
    v_add_u32 v150, v105, v65
    buffer_store_dwordx2 v[148:149], v150, s[44:47], 0 offen
    s_lshl_b32 s28, s83, 4
    s_add_u32 s28, s28, s21
    s_cmp_lt_u32 s28, 640
    s_cselect_b32 s29, 1051011932, 1.0
    s_lshr_b32 s28, s28, 2
    v_add_u32 v192, s28, v19
    v_mul_u32_u24 v193, 0xcccd, v192
    v_lshrrev_b32 v193, 18, v193
    v_mul_u32_u24 v194, 5, v193
    v_sub_u32 v192, v192, v194
    v_cmp_lt_u32 vcc, 63, v193
    v_mul_u32_u24 v193, 98304, v193
    v_lshlrev_b32 v195, 2, v192
    v_cndmask_b32 v195, 0, v195, vcc
    v_lshl_add_u32 v192, v192, 8, v193
    v_mul_f32 v72, s29, v25
    v_mul_f32 v74, s29, v27
    v_pk_fma_f32 v[152:153], v[24:25], v[44:45], v[152:153] op_sel_hi:[0,1,1] neg_lo:[1,0,0] neg_hi:[1,0,0]
    v_pk_fma_f32 v[154:155], v[24:25], v[46:47], v[154:155] op_sel_hi:[0,1,1] neg_lo:[1,0,0] neg_hi:[1,0,0]
    v_pk_mul_f32 v[152:153], v[72:73], v[152:153] op_sel_hi:[0,1]
    v_pk_mul_f32 v[154:155], v[72:73], v[154:155] op_sel_hi:[0,1]
    v_add_u32 v104, v195, v68
    v_cvt_pk_bf16_f32 v152, v152, v153
    v_and_b32 v104, 31, v104
    v_cvt_pk_bf16_f32 v153, v154, v155
    v_lshl_add_u32 v104, v104, 3, v192
    v_add_u32 v154, v104, v64
    buffer_store_dwordx2 v[152:153], v154, s[44:47], 0 offen
    v_pk_fma_f32 v[156:157], v[26:27], v[44:45], v[156:157] op_sel_hi:[0,1,1] neg_lo:[1,0,0] neg_hi:[1,0,0]
    v_pk_fma_f32 v[158:159], v[26:27], v[46:47], v[158:159] op_sel_hi:[0,1,1] neg_lo:[1,0,0] neg_hi:[1,0,0]
    v_pk_mul_f32 v[156:157], v[74:75], v[156:157] op_sel_hi:[0,1]
    v_pk_mul_f32 v[158:159], v[74:75], v[158:159] op_sel_hi:[0,1]
    v_add_u32 v105, v195, v69
    v_cvt_pk_bf16_f32 v156, v156, v157
    v_and_b32 v105, 31, v105
    v_cvt_pk_bf16_f32 v157, v158, v159
    v_lshl_add_u32 v105, v105, 3, v192
    v_add_u32 v158, v105, v65
    buffer_store_dwordx2 v[156:157], v158, s[44:47], 0 offen
    s_lshl_b32 s28, s84, 4
    s_add_u32 s28, s28, s21
    s_cmp_lt_u32 s28, 640
    s_cselect_b32 s29, 1051011932, 1.0
    s_lshr_b32 s28, s28, 2
    v_add_u32 v192, s28, v19
    v_mul_u32_u24 v193, 0xcccd, v192
    v_lshrrev_b32 v193, 18, v193
    v_mul_u32_u24 v194, 5, v193
    v_sub_u32 v192, v192, v194
    v_cmp_lt_u32 vcc, 63, v193
    v_mul_u32_u24 v193, 98304, v193
    v_lshlrev_b32 v195, 2, v192
    v_cndmask_b32 v195, 0, v195, vcc
    v_lshl_add_u32 v192, v192, 8, v193
    v_mul_f32 v72, s29, v25
    v_mul_f32 v74, s29, v27
    v_pk_fma_f32 v[160:161], v[24:25], v[48:49], v[160:161] op_sel_hi:[0,1,1] neg_lo:[1,0,0] neg_hi:[1,0,0]
    v_pk_fma_f32 v[162:163], v[24:25], v[50:51], v[162:163] op_sel_hi:[0,1,1] neg_lo:[1,0,0] neg_hi:[1,0,0]
    v_pk_mul_f32 v[160:161], v[72:73], v[160:161] op_sel_hi:[0,1]
    v_pk_mul_f32 v[162:163], v[72:73], v[162:163] op_sel_hi:[0,1]
    v_add_u32 v104, v195, v68
    v_cvt_pk_bf16_f32 v160, v160, v161
    v_and_b32 v104, 31, v104
    v_cvt_pk_bf16_f32 v161, v162, v163
    v_lshl_add_u32 v104, v104, 3, v192
    v_add_u32 v162, v104, v64
    buffer_store_dwordx2 v[160:161], v162, s[44:47], 0 offen
    v_pk_fma_f32 v[164:165], v[26:27], v[48:49], v[164:165] op_sel_hi:[0,1,1] neg_lo:[1,0,0] neg_hi:[1,0,0]
    v_pk_fma_f32 v[166:167], v[26:27], v[50:51], v[166:167] op_sel_hi:[0,1,1] neg_lo:[1,0,0] neg_hi:[1,0,0]
    v_pk_mul_f32 v[164:165], v[74:75], v[164:165] op_sel_hi:[0,1]
    v_pk_mul_f32 v[166:167], v[74:75], v[166:167] op_sel_hi:[0,1]
    v_add_u32 v105, v195, v69
    v_cvt_pk_bf16_f32 v164, v164, v165
    v_and_b32 v105, 31, v105
    v_cvt_pk_bf16_f32 v165, v166, v167
    v_lshl_add_u32 v105, v105, 3, v192
    v_add_u32 v166, v105, v65
    buffer_store_dwordx2 v[164:165], v166, s[44:47], 0 offen
    s_lshl_b32 s28, s85, 4
    s_add_u32 s28, s28, s21
    s_cmp_lt_u32 s28, 640
    s_cselect_b32 s29, 1051011932, 1.0
    s_lshr_b32 s28, s28, 2
    v_add_u32 v192, s28, v19
    v_mul_u32_u24 v193, 0xcccd, v192
    v_lshrrev_b32 v193, 18, v193
    v_mul_u32_u24 v194, 5, v193
    v_sub_u32 v192, v192, v194
    v_cmp_lt_u32 vcc, 63, v193
    v_mul_u32_u24 v193, 98304, v193
    v_lshlrev_b32 v195, 2, v192
    v_cndmask_b32 v195, 0, v195, vcc
    v_lshl_add_u32 v192, v192, 8, v193
    v_mul_f32 v72, s29, v25
    v_mul_f32 v74, s29, v27
    v_pk_fma_f32 v[168:169], v[24:25], v[52:53], v[168:169] op_sel_hi:[0,1,1] neg_lo:[1,0,0] neg_hi:[1,0,0]
    v_pk_fma_f32 v[170:171], v[24:25], v[54:55], v[170:171] op_sel_hi:[0,1,1] neg_lo:[1,0,0] neg_hi:[1,0,0]
    v_pk_mul_f32 v[168:169], v[72:73], v[168:169] op_sel_hi:[0,1]
    v_pk_mul_f32 v[170:171], v[72:73], v[170:171] op_sel_hi:[0,1]
    v_add_u32 v104, v195, v68
    v_cvt_pk_bf16_f32 v168, v168, v169
    v_and_b32 v104, 31, v104
    v_cvt_pk_bf16_f32 v169, v170, v171
    v_lshl_add_u32 v104, v104, 3, v192
    v_add_u32 v170, v104, v64
    buffer_store_dwordx2 v[168:169], v170, s[44:47], 0 offen
    v_pk_fma_f32 v[172:173], v[26:27], v[52:53], v[172:173] op_sel_hi:[0,1,1] neg_lo:[1,0,0] neg_hi:[1,0,0]
    v_pk_fma_f32 v[174:175], v[26:27], v[54:55], v[174:175] op_sel_hi:[0,1,1] neg_lo:[1,0,0] neg_hi:[1,0,0]
    v_pk_mul_f32 v[172:173], v[74:75], v[172:173] op_sel_hi:[0,1]
    v_pk_mul_f32 v[174:175], v[74:75], v[174:175] op_sel_hi:[0,1]
    v_add_u32 v105, v195, v69
    v_cvt_pk_bf16_f32 v172, v172, v173
    v_and_b32 v105, 31, v105
    v_cvt_pk_bf16_f32 v173, v174, v175
    v_lshl_add_u32 v105, v105, 3, v192
    v_add_u32 v174, v105, v65
    buffer_store_dwordx2 v[172:173], v174, s[44:47], 0 offen
    s_lshl_b32 s28, s86, 4
    s_add_u32 s28, s28, s21
    s_cmp_lt_u32 s28, 640
    s_cselect_b32 s29, 1051011932, 1.0
    s_lshr_b32 s28, s28, 2
    v_add_u32 v192, s28, v19
    v_mul_u32_u24 v193, 0xcccd, v192
    v_lshrrev_b32 v193, 18, v193
    v_mul_u32_u24 v194, 5, v193
    v_sub_u32 v192, v192, v194
    v_cmp_lt_u32 vcc, 63, v193
    v_mul_u32_u24 v193, 98304, v193
    v_lshlrev_b32 v195, 2, v192
    v_cndmask_b32 v195, 0, v195, vcc
    v_lshl_add_u32 v192, v192, 8, v193
    v_mul_f32 v72, s29, v25
    v_mul_f32 v74, s29, v27
    v_pk_fma_f32 v[176:177], v[24:25], v[56:57], v[176:177] op_sel_hi:[0,1,1] neg_lo:[1,0,0] neg_hi:[1,0,0]
    v_pk_fma_f32 v[178:179], v[24:25], v[58:59], v[178:179] op_sel_hi:[0,1,1] neg_lo:[1,0,0] neg_hi:[1,0,0]
    v_pk_mul_f32 v[176:177], v[72:73], v[176:177] op_sel_hi:[0,1]
    v_pk_mul_f32 v[178:179], v[72:73], v[178:179] op_sel_hi:[0,1]
    v_add_u32 v104, v195, v68
    v_cvt_pk_bf16_f32 v176, v176, v177
    v_and_b32 v104, 31, v104
    v_cvt_pk_bf16_f32 v177, v178, v179
    v_lshl_add_u32 v104, v104, 3, v192
    v_add_u32 v178, v104, v64
    buffer_store_dwordx2 v[176:177], v178, s[44:47], 0 offen
    v_pk_fma_f32 v[180:181], v[26:27], v[56:57], v[180:181] op_sel_hi:[0,1,1] neg_lo:[1,0,0] neg_hi:[1,0,0]
    v_pk_fma_f32 v[182:183], v[26:27], v[58:59], v[182:183] op_sel_hi:[0,1,1] neg_lo:[1,0,0] neg_hi:[1,0,0]
    v_pk_mul_f32 v[180:181], v[74:75], v[180:181] op_sel_hi:[0,1]
    v_pk_mul_f32 v[182:183], v[74:75], v[182:183] op_sel_hi:[0,1]
    v_add_u32 v105, v195, v69
    v_cvt_pk_bf16_f32 v180, v180, v181
    v_and_b32 v105, 31, v105
    v_cvt_pk_bf16_f32 v181, v182, v183
    v_lshl_add_u32 v105, v105, 3, v192
    v_add_u32 v182, v105, v65
    buffer_store_dwordx2 v[180:181], v182, s[44:47], 0 offen
    s_cmp_lt_u32 s27, 8
    s_cbranch_scc1 L_k1_fin
    s_lshl_b32 s28, s87, 4
    s_add_u32 s28, s28, s21
    s_cmp_lt_u32 s28, 640
    s_cselect_b32 s29, 1051011932, 1.0
    s_lshr_b32 s28, s28, 2
    v_add_u32 v192, s28, v19
    v_mul_u32_u24 v193, 0xcccd, v192
    v_lshrrev_b32 v193, 18, v193
    v_mul_u32_u24 v194, 5, v193
    v_sub_u32 v192, v192, v194
    v_cmp_lt_u32 vcc, 63, v193
    v_mul_u32_u24 v193, 98304, v193
    v_lshlrev_b32 v195, 2, v192
    v_cndmask_b32 v195, 0, v195, vcc
    v_lshl_add_u32 v192, v192, 8, v193
    v_mul_f32 v72, s29, v25
    v_mul_f32 v74, s29, v27
    v_pk_fma_f32 v[184:185], v[24:25], v[60:61], v[184:185] op_sel_hi:[0,1,1] neg_lo:[1,0,0] neg_hi:[1,0,0]
    v_pk_fma_f32 v[186:187], v[24:25], v[62:63], v[186:187] op_sel_hi:[0,1,1] neg_lo:[1,0,0] neg_hi:[1,0,0]
    v_pk_mul_f32 v[184:185], v[72:73], v[184:185] op_sel_hi:[0,1]
    v_pk_mul_f32 v[186:187], v[72:73], v[186:187] op_sel_hi:[0,1]
    v_add_u32 v104, v195, v68
    v_cvt_pk_bf16_f32 v184, v184, v185
    v_and_b32 v104, 31, v104
    v_cvt_pk_bf16_f32 v185, v186, v187
    v_lshl_add_u32 v104, v104, 3, v192
    v_add_u32 v186, v104, v64
    buffer_store_dwordx2 v[184:185], v186, s[44:47], 0 offen
    v_pk_fma_f32 v[188:189], v[26:27], v[60:61], v[188:189] op_sel_hi:[0,1,1] neg_lo:[1,0,0] neg_hi:[1,0,0]
    v_pk_fma_f32 v[190:191], v[26:27], v[62:63], v[190:191] op_sel_hi:[0,1,1] neg_lo:[1,0,0] neg_hi:[1,0,0]
    v_pk_mul_f32 v[188:189], v[74:75], v[188:189] op_sel_hi:[0,1]
    v_pk_mul_f32 v[190:191], v[74:75], v[190:191] op_sel_hi:[0,1]
    v_add_u32 v105, v195, v69
    v_cvt_pk_bf16_f32 v188, v188, v189
    v_and_b32 v105, 31, v105
    v_cvt_pk_bf16_f32 v189, v190, v191
    v_lshl_add_u32 v105, v105, 3, v192
    v_add_u32 v190, v105, v65
    buffer_store_dwordx2 v[188:189], v190, s[44:47], 0 offen
    s_branch L_k1_fin
L_k1_mlp:
    s_add_u32 s28, s18, 0
    s_and_b32 s28, s28, 1
    s_lshl_b32 s29, s17, 1
    s_add_u32 s28, s28, s29
    s_lshl_b32 s29, s19, 3
    s_add_u32 s28, s28, s29
    s_mul_i32 s28, s28, 69632
    v_lshl_add_u32 v64, v18, 4, s28
    s_add_u32 s28, s18, 1
    s_and_b32 s28, s28, 1
    s_lshl_b32 s29, s17, 1
    s_add_u32 s28, s28, s29
    s_lshl_b32 s29, s19, 3
    s_add_u32 s28, s28, s29
    s_mul_i32 s28, s28, 69632
    v_lshl_add_u32 v65, v18, 4, s28
    v_mov_b32 v76, 3184710632
    v_mov_b32 v77, 3222493025
    v_mov_b32 v78, 1.0
    v_mov_b32 v79, 1.0
    s_waitcnt vmcnt(0)
    s_lshl_b32 s28, s80, 4
    s_add_u32 s28, s28, s21
    s_lshr_b32 s28, s28, 2
    s_add_u32 s28, s28, 160
    v_add_u32 v192, s28, v19
    v_lshrrev_b32 v193, 3, v192
    v_lshlrev_b32 v193, 10, v193
    v_and_b32 v194, 3, v192
    v_lshl_add_u32 v193, v194, 8, v193
    v_bfe_u32 v194, v192, 2, 1
    v_lshl_add_u32 v192, v194, 3, v193
    v_lshlrev_b32 v88, 16, v220
    v_and_b32 v89, 0xffff0000, v220
    v_lshlrev_b32 v90, 16, v221
    v_and_b32 v91, 0xffff0000, v221
    v_pk_fma_f32 v[128:129], v[24:25], v[32:33], v[128:129] op_sel_hi:[0,1,1] neg_lo:[1,0,0] neg_hi:[1,0,0]
    v_pk_fma_f32 v[130:131], v[24:25], v[34:35], v[130:131] op_sel_hi:[0,1,1] neg_lo:[1,0,0] neg_hi:[1,0,0]
    v_pk_fma_f32 v[132:133], v[26:27], v[32:33], v[132:133] op_sel_hi:[0,1,1] neg_lo:[1,0,0] neg_hi:[1,0,0]
    v_pk_fma_f32 v[134:135], v[26:27], v[34:35], v[134:135] op_sel_hi:[0,1,1] neg_lo:[1,0,0] neg_hi:[1,0,0]
    v_pk_fma_f32 v[128:129], v[24:25], v[128:129], v[88:89] op_sel:[1,0,0] op_sel_hi:[1,1,1]
    v_pk_fma_f32 v[130:131], v[24:25], v[130:131], v[90:91] op_sel:[1,0,0] op_sel_hi:[1,1,1]
    v_pk_fma_f32 v[132:133], v[26:27], v[132:133], v[88:89] op_sel:[1,0,0] op_sel_hi:[1,1,1]
    v_pk_fma_f32 v[134:135], v[26:27], v[134:135], v[90:91] op_sel:[1,0,0] op_sel_hi:[1,1,1]
    v_pk_mul_f32 v[112:113], v[128:129], v[128:129]
    v_pk_mul_f32 v[114:115], v[130:131], v[130:131]
    v_pk_mul_f32 v[116:117], v[132:133], v[132:133]
    v_pk_mul_f32 v[118:119], v[134:135], v[134:135]
    v_pk_fma_f32 v[112:113], v[112:113], v[76:77], v[76:77] op_sel:[0,0,1] op_sel_hi:[1,0,1]
    v_pk_fma_f32 v[114:115], v[114:115], v[76:77], v[76:77] op_sel:[0,0,1] op_sel_hi:[1,0,1]
    v_pk_fma_f32 v[116:117], v[116:117], v[76:77], v[76:77] op_sel:[0,0,1] op_sel_hi:[1,0,1]
    v_pk_fma_f32 v[118:119], v[118:119], v[76:77], v[76:77] op_sel:[0,0,1] op_sel_hi:[1,0,1]
    v_pk_mul_f32 v[112:113], v[112:113], v[128:129]
    v_pk_mul_f32 v[114:115], v[114:115], v[130:131]
    v_pk_mul_f32 v[116:117], v[116:117], v[132:133]
    v_pk_mul_f32 v[118:119], v[118:119], v[134:135]
    v_exp_f32 v112, v112
    v_exp_f32 v113, v113
    v_exp_f32 v114, v114
    v_exp_f32 v115, v115
    v_exp_f32 v116, v116
    v_exp_f32 v117, v117
    v_exp_f32 v118, v118
    v_exp_f32 v119, v119
    v_pk_add_f32 v[112:113], v[112:113], v[78:79]
    v_pk_add_f32 v[114:115], v[114:115], v[78:79]
    v_pk_add_f32 v[116:117], v[116:117], v[78:79]
    v_pk_add_f32 v[118:119], v[118:119], v[78:79]
    v_rcp_f32 v112, v112
    v_rcp_f32 v113, v113
    v_rcp_f32 v114, v114
    v_rcp_f32 v115, v115
    v_rcp_f32 v116, v116
    v_rcp_f32 v117, v117
    v_rcp_f32 v118, v118
    v_rcp_f32 v119, v119
    v_pk_mul_f32 v[128:129], v[128:129], v[112:113]
    v_pk_mul_f32 v[130:131], v[130:131], v[114:115]
    v_pk_mul_f32 v[132:133], v[132:133], v[116:117]
    v_pk_mul_f32 v[134:135], v[134:135], v[118:119]
    v_cvt_pk_bf16_f32 v128, v128, v129
    v_cvt_pk_bf16_f32 v129, v130, v131
    v_add_u32 v130, v192, v64
    buffer_store_dwordx2 v[128:129], v130, s[48:51], 0 offen
    v_cvt_pk_bf16_f32 v132, v132, v133
    v_cvt_pk_bf16_f32 v133, v134, v135
    v_add_u32 v134, v192, v65
    buffer_store_dwordx2 v[132:133], v134, s[48:51], 0 offen
    s_lshl_b32 s28, s81, 4
    s_add_u32 s28, s28, s21
    s_lshr_b32 s28, s28, 2
    s_add_u32 s28, s28, 160
    v_add_u32 v192, s28, v19
    v_lshrrev_b32 v193, 3, v192
    v_lshlrev_b32 v193, 10, v193
    v_and_b32 v194, 3, v192
    v_lshl_add_u32 v193, v194, 8, v193
    v_bfe_u32 v194, v192, 2, 1
    v_lshl_add_u32 v192, v194, 3, v193
    v_lshlrev_b32 v88, 16, v222
    v_and_b32 v89, 0xffff0000, v222
    v_lshlrev_b32 v90, 16, v223
    v_and_b32 v91, 0xffff0000, v223
    v_pk_fma_f32 v[136:137], v[24:25], v[36:37], v[136:137] op_sel_hi:[0,1,1] neg_lo:[1,0,0] neg_hi:[1,0,0]
    v_pk_fma_f32 v[138:139], v[24:25], v[38:39], v[138:139] op_sel_hi:[0,1,1] neg_lo:[1,0,0] neg_hi:[1,0,0]
    v_pk_fma_f32 v[140:141], v[26:27], v[36:37], v[140:141] op_sel_hi:[0,1,1] neg_lo:[1,0,0] neg_hi:[1,0,0]
    v_pk_fma_f32 v[142:143], v[26:27], v[38:39], v[142:143] op_sel_hi:[0,1,1] neg_lo:[1,0,0] neg_hi:[1,0,0]
    v_pk_fma_f32 v[136:137], v[24:25], v[136:137], v[88:89] op_sel:[1,0,0] op_sel_hi:[1,1,1]
    v_pk_fma_f32 v[138:139], v[24:25], v[138:139], v[90:91] op_sel:[1,0,0] op_sel_hi:[1,1,1]
    v_pk_fma_f32 v[140:141], v[26:27], v[140:141], v[88:89] op_sel:[1,0,0] op_sel_hi:[1,1,1]
    v_pk_fma_f32 v[142:143], v[26:27], v[142:143], v[90:91] op_sel:[1,0,0] op_sel_hi:[1,1,1]
    v_pk_mul_f32 v[112:113], v[136:137], v[136:137]
    v_pk_mul_f32 v[114:115], v[138:139], v[138:139]
    v_pk_mul_f32 v[116:117], v[140:141], v[140:141]
    v_pk_mul_f32 v[118:119], v[142:143], v[142:143]
    v_pk_fma_f32 v[112:113], v[112:113], v[76:77], v[76:77] op_sel:[0,0,1] op_sel_hi:[1,0,1]
    v_pk_fma_f32 v[114:115], v[114:115], v[76:77], v[76:77] op_sel:[0,0,1] op_sel_hi:[1,0,1]
    v_pk_fma_f32 v[116:117], v[116:117], v[76:77], v[76:77] op_sel:[0,0,1] op_sel_hi:[1,0,1]
    v_pk_fma_f32 v[118:119], v[118:119], v[76:77], v[76:77] op_sel:[0,0,1] op_sel_hi:[1,0,1]
    v_pk_mul_f32 v[112:113], v[112:113], v[136:137]
    v_pk_mul_f32 v[114:115], v[114:115], v[138:139]
    v_pk_mul_f32 v[116:117], v[116:117], v[140:141]
    v_pk_mul_f32 v[118:119], v[118:119], v[142:143]
    v_exp_f32 v112, v112
    v_exp_f32 v113, v113
    v_exp_f32 v114, v114
    v_exp_f32 v115, v115
    v_exp_f32 v116, v116
    v_exp_f32 v117, v117
    v_exp_f32 v118, v118
    v_exp_f32 v119, v119
    v_pk_add_f32 v[112:113], v[112:113], v[78:79]
    v_pk_add_f32 v[114:115], v[114:115], v[78:79]
    v_pk_add_f32 v[116:117], v[116:117], v[78:79]
    v_pk_add_f32 v[118:119], v[118:119], v[78:79]
    v_rcp_f32 v112, v112
    v_rcp_f32 v113, v113
    v_rcp_f32 v114, v114
    v_rcp_f32 v115, v115
    v_rcp_f32 v116, v116
    v_rcp_f32 v117, v117
    v_rcp_f32 v118, v118
    v_rcp_f32 v119, v119
    v_pk_mul_f32 v[136:137], v[136:137], v[112:113]
    v_pk_mul_f32 v[138:139], v[138:139], v[114:115]
    v_pk_mul_f32 v[140:141], v[140:141], v[116:117]
    v_pk_mul_f32 v[142:143], v[142:143], v[118:119]
    v_cvt_pk_bf16_f32 v136, v136, v137
    v_cvt_pk_bf16_f32 v137, v138, v139
    v_add_u32 v138, v192, v64
    buffer_store_dwordx2 v[136:137], v138, s[48:51], 0 offen
    v_cvt_pk_bf16_f32 v140, v140, v141
    v_cvt_pk_bf16_f32 v141, v142, v143
    v_add_u32 v142, v192, v65
    buffer_store_dwordx2 v[140:141], v142, s[48:51], 0 offen
    s_lshl_b32 s28, s82, 4
    s_add_u32 s28, s28, s21
    s_lshr_b32 s28, s28, 2
    s_add_u32 s28, s28, 160
    v_add_u32 v192, s28, v19
    v_lshrrev_b32 v193, 3, v192
    v_lshlrev_b32 v193, 10, v193
    v_and_b32 v194, 3, v192
    v_lshl_add_u32 v193, v194, 8, v193
    v_bfe_u32 v194, v192, 2, 1
    v_lshl_add_u32 v192, v194, 3, v193
    v_lshlrev_b32 v88, 16, v224
    v_and_b32 v89, 0xffff0000, v224
    v_lshlrev_b32 v90, 16, v225
    v_and_b32 v91, 0xffff0000, v225
    v_pk_fma_f32 v[144:145], v[24:25], v[40:41], v[144:145] op_sel_hi:[0,1,1] neg_lo:[1,0,0] neg_hi:[1,0,0]
    v_pk_fma_f32 v[146:147], v[24:25], v[42:43], v[146:147] op_sel_hi:[0,1,1] neg_lo:[1,0,0] neg_hi:[1,0,0]
    v_pk_fma_f32 v[148:149], v[26:27], v[40:41], v[148:149] op_sel_hi:[0,1,1] neg_lo:[1,0,0] neg_hi:[1,0,0]
    v_pk_fma_f32 v[150:151], v[26:27], v[42:43], v[150:151] op_sel_hi:[0,1,1] neg_lo:[1,0,0] neg_hi:[1,0,0]
    v_pk_fma_f32 v[144:145], v[24:25], v[144:145], v[88:89] op_sel:[1,0,0] op_sel_hi:[1,1,1]
    v_pk_fma_f32 v[146:147], v[24:25], v[146:147], v[90:91] op_sel:[1,0,0] op_sel_hi:[1,1,1]
    v_pk_fma_f32 v[148:149], v[26:27], v[148:149], v[88:89] op_sel:[1,0,0] op_sel_hi:[1,1,1]
    v_pk_fma_f32 v[150:151], v[26:27], v[150:151], v[90:91] op_sel:[1,0,0] op_sel_hi:[1,1,1]
    v_pk_mul_f32 v[112:113], v[144:145], v[144:145]
    v_pk_mul_f32 v[114:115], v[146:147], v[146:147]
    v_pk_mul_f32 v[116:117], v[148:149], v[148:149]
    v_pk_mul_f32 v[118:119], v[150:151], v[150:151]
    v_pk_fma_f32 v[112:113], v[112:113], v[76:77], v[76:77] op_sel:[0,0,1] op_sel_hi:[1,0,1]
    v_pk_fma_f32 v[114:115], v[114:115], v[76:77], v[76:77] op_sel:[0,0,1] op_sel_hi:[1,0,1]
    v_pk_fma_f32 v[116:117], v[116:117], v[76:77], v[76:77] op_sel:[0,0,1] op_sel_hi:[1,0,1]
    v_pk_fma_f32 v[118:119], v[118:119], v[76:77], v[76:77] op_sel:[0,0,1] op_sel_hi:[1,0,1]
    v_pk_mul_f32 v[112:113], v[112:113], v[144:145]
    v_pk_mul_f32 v[114:115], v[114:115], v[146:147]
    v_pk_mul_f32 v[116:117], v[116:117], v[148:149]
    v_pk_mul_f32 v[118:119], v[118:119], v[150:151]
    v_exp_f32 v112, v112
    v_exp_f32 v113, v113
    v_exp_f32 v114, v114
    v_exp_f32 v115, v115
    v_exp_f32 v116, v116
    v_exp_f32 v117, v117
    v_exp_f32 v118, v118
    v_exp_f32 v119, v119
    v_pk_add_f32 v[112:113], v[112:113], v[78:79]
    v_pk_add_f32 v[114:115], v[114:115], v[78:79]
    v_pk_add_f32 v[116:117], v[116:117], v[78:79]
    v_pk_add_f32 v[118:119], v[118:119], v[78:79]
    v_rcp_f32 v112, v112
    v_rcp_f32 v113, v113
    v_rcp_f32 v114, v114
    v_rcp_f32 v115, v115
    v_rcp_f32 v116, v116
    v_rcp_f32 v117, v117
    v_rcp_f32 v118, v118
    v_rcp_f32 v119, v119
    v_pk_mul_f32 v[144:145], v[144:145], v[112:113]
    v_pk_mul_f32 v[146:147], v[146:147], v[114:115]
    v_pk_mul_f32 v[148:149], v[148:149], v[116:117]
    v_pk_mul_f32 v[150:151], v[150:151], v[118:119]
    v_cvt_pk_bf16_f32 v144, v144, v145
    v_cvt_pk_bf16_f32 v145, v146, v147
    v_add_u32 v146, v192, v64
    buffer_store_dwordx2 v[144:145], v146, s[48:51], 0 offen
    v_cvt_pk_bf16_f32 v148, v148, v149
    v_cvt_pk_bf16_f32 v149, v150, v151
    v_add_u32 v150, v192, v65
    buffer_store_dwordx2 v[148:149], v150, s[48:51], 0 offen
    s_lshl_b32 s28, s83, 4
    s_add_u32 s28, s28, s21
    s_lshr_b32 s28, s28, 2
    s_add_u32 s28, s28, 160
    v_add_u32 v192, s28, v19
    v_lshrrev_b32 v193, 3, v192
    v_lshlrev_b32 v193, 10, v193
    v_and_b32 v194, 3, v192
    v_lshl_add_u32 v193, v194, 8, v193
    v_bfe_u32 v194, v192, 2, 1
    v_lshl_add_u32 v192, v194, 3, v193
    v_lshlrev_b32 v88, 16, v226
    v_and_b32 v89, 0xffff0000, v226
    v_lshlrev_b32 v90, 16, v227
    v_and_b32 v91, 0xffff0000, v227
    v_pk_fma_f32 v[152:153], v[24:25], v[44:45], v[152:153] op_sel_hi:[0,1,1] neg_lo:[1,0,0] neg_hi:[1,0,0]
    v_pk_fma_f32 v[154:155], v[24:25], v[46:47], v[154:155] op_sel_hi:[0,1,1] neg_lo:[1,0,0] neg_hi:[1,0,0]
    v_pk_fma_f32 v[156:157], v[26:27], v[44:45], v[156:157] op_sel_hi:[0,1,1] neg_lo:[1,0,0] neg_hi:[1,0,0]
    v_pk_fma_f32 v[158:159], v[26:27], v[46:47], v[158:159] op_sel_hi:[0,1,1] neg_lo:[1,0,0] neg_hi:[1,0,0]
    v_pk_fma_f32 v[152:153], v[24:25], v[152:153], v[88:89] op_sel:[1,0,0] op_sel_hi:[1,1,1]
    v_pk_fma_f32 v[154:155], v[24:25], v[154:155], v[90:91] op_sel:[1,0,0] op_sel_hi:[1,1,1]
    v_pk_fma_f32 v[156:157], v[26:27], v[156:157], v[88:89] op_sel:[1,0,0] op_sel_hi:[1,1,1]
    v_pk_fma_f32 v[158:159], v[26:27], v[158:159], v[90:91] op_sel:[1,0,0] op_sel_hi:[1,1,1]
    v_pk_mul_f32 v[112:113], v[152:153], v[152:153]
    v_pk_mul_f32 v[114:115], v[154:155], v[154:155]
    v_pk_mul_f32 v[116:117], v[156:157], v[156:157]
    v_pk_mul_f32 v[118:119], v[158:159], v[158:159]
    v_pk_fma_f32 v[112:113], v[112:113], v[76:77], v[76:77] op_sel:[0,0,1] op_sel_hi:[1,0,1]
    v_pk_fma_f32 v[114:115], v[114:115], v[76:77], v[76:77] op_sel:[0,0,1] op_sel_hi:[1,0,1]
    v_pk_fma_f32 v[116:117], v[116:117], v[76:77], v[76:77] op_sel:[0,0,1] op_sel_hi:[1,0,1]
    v_pk_fma_f32 v[118:119], v[118:119], v[76:77], v[76:77] op_sel:[0,0,1] op_sel_hi:[1,0,1]
    v_pk_mul_f32 v[112:113], v[112:113], v[152:153]
    v_pk_mul_f32 v[114:115], v[114:115], v[154:155]
    v_pk_mul_f32 v[116:117], v[116:117], v[156:157]
    v_pk_mul_f32 v[118:119], v[118:119], v[158:159]
    v_exp_f32 v112, v112
    v_exp_f32 v113, v113
    v_exp_f32 v114, v114
    v_exp_f32 v115, v115
    v_exp_f32 v116, v116
    v_exp_f32 v117, v117
    v_exp_f32 v118, v118
    v_exp_f32 v119, v119
    v_pk_add_f32 v[112:113], v[112:113], v[78:79]
    v_pk_add_f32 v[114:115], v[114:115], v[78:79]
    v_pk_add_f32 v[116:117], v[116:117], v[78:79]
    v_pk_add_f32 v[118:119], v[118:119], v[78:79]
    v_rcp_f32 v112, v112
    v_rcp_f32 v113, v113
    v_rcp_f32 v114, v114
    v_rcp_f32 v115, v115
    v_rcp_f32 v116, v116
    v_rcp_f32 v117, v117
    v_rcp_f32 v118, v118
    v_rcp_f32 v119, v119
    v_pk_mul_f32 v[152:153], v[152:153], v[112:113]
    v_pk_mul_f32 v[154:155], v[154:155], v[114:115]
    v_pk_mul_f32 v[156:157], v[156:157], v[116:117]
    v_pk_mul_f32 v[158:159], v[158:159], v[118:119]
    v_cvt_pk_bf16_f32 v152, v152, v153
    v_cvt_pk_bf16_f32 v153, v154, v155
    v_add_u32 v154, v192, v64
    buffer_store_dwordx2 v[152:153], v154, s[48:51], 0 offen
    v_cvt_pk_bf16_f32 v156, v156, v157
    v_cvt_pk_bf16_f32 v157, v158, v159
    v_add_u32 v158, v192, v65
    buffer_store_dwordx2 v[156:157], v158, s[48:51], 0 offen
    s_lshl_b32 s28, s84, 4
    s_add_u32 s28, s28, s21
    s_lshr_b32 s28, s28, 2
    s_add_u32 s28, s28, 160
    v_add_u32 v192, s28, v19
    v_lshrrev_b32 v193, 3, v192
    v_lshlrev_b32 v193, 10, v193
    v_and_b32 v194, 3, v192
    v_lshl_add_u32 v193, v194, 8, v193
    v_bfe_u32 v194, v192, 2, 1
    v_lshl_add_u32 v192, v194, 3, v193
    v_lshlrev_b32 v88, 16, v228
    v_and_b32 v89, 0xffff0000, v228
    v_lshlrev_b32 v90, 16, v229
    v_and_b32 v91, 0xffff0000, v229
    v_pk_fma_f32 v[160:161], v[24:25], v[48:49], v[160:161] op_sel_hi:[0,1,1] neg_lo:[1,0,0] neg_hi:[1,0,0]
    v_pk_fma_f32 v[162:163], v[24:25], v[50:51], v[162:163] op_sel_hi:[0,1,1] neg_lo:[1,0,0] neg_hi:[1,0,0]
    v_pk_fma_f32 v[164:165], v[26:27], v[48:49], v[164:165] op_sel_hi:[0,1,1] neg_lo:[1,0,0] neg_hi:[1,0,0]
    v_pk_fma_f32 v[166:167], v[26:27], v[50:51], v[166:167] op_sel_hi:[0,1,1] neg_lo:[1,0,0] neg_hi:[1,0,0]
    v_pk_fma_f32 v[160:161], v[24:25], v[160:161], v[88:89] op_sel:[1,0,0] op_sel_hi:[1,1,1]
    v_pk_fma_f32 v[162:163], v[24:25], v[162:163], v[90:91] op_sel:[1,0,0] op_sel_hi:[1,1,1]
    v_pk_fma_f32 v[164:165], v[26:27], v[164:165], v[88:89] op_sel:[1,0,0] op_sel_hi:[1,1,1]
    v_pk_fma_f32 v[166:167], v[26:27], v[166:167], v[90:91] op_sel:[1,0,0] op_sel_hi:[1,1,1]
    v_pk_mul_f32 v[112:113], v[160:161], v[160:161]
    v_pk_mul_f32 v[114:115], v[162:163], v[162:163]
    v_pk_mul_f32 v[116:117], v[164:165], v[164:165]
    v_pk_mul_f32 v[118:119], v[166:167], v[166:167]
    v_pk_fma_f32 v[112:113], v[112:113], v[76:77], v[76:77] op_sel:[0,0,1] op_sel_hi:[1,0,1]
    v_pk_fma_f32 v[114:115], v[114:115], v[76:77], v[76:77] op_sel:[0,0,1] op_sel_hi:[1,0,1]
    v_pk_fma_f32 v[116:117], v[116:117], v[76:77], v[76:77] op_sel:[0,0,1] op_sel_hi:[1,0,1]
    v_pk_fma_f32 v[118:119], v[118:119], v[76:77], v[76:77] op_sel:[0,0,1] op_sel_hi:[1,0,1]
    v_pk_mul_f32 v[112:113], v[112:113], v[160:161]
    v_pk_mul_f32 v[114:115], v[114:115], v[162:163]
    v_pk_mul_f32 v[116:117], v[116:117], v[164:165]
    v_pk_mul_f32 v[118:119], v[118:119], v[166:167]
    v_exp_f32 v112, v112
    v_exp_f32 v113, v113
    v_exp_f32 v114, v114
    v_exp_f32 v115, v115
    v_exp_f32 v116, v116
    v_exp_f32 v117, v117
    v_exp_f32 v118, v118
    v_exp_f32 v119, v119
    v_pk_add_f32 v[112:113], v[112:113], v[78:79]
    v_pk_add_f32 v[114:115], v[114:115], v[78:79]
    v_pk_add_f32 v[116:117], v[116:117], v[78:79]
    v_pk_add_f32 v[118:119], v[118:119], v[78:79]
    v_rcp_f32 v112, v112
    v_rcp_f32 v113, v113
    v_rcp_f32 v114, v114
    v_rcp_f32 v115, v115
    v_rcp_f32 v116, v116
    v_rcp_f32 v117, v117
    v_rcp_f32 v118, v118
    v_rcp_f32 v119, v119
    v_pk_mul_f32 v[160:161], v[160:161], v[112:113]
    v_pk_mul_f32 v[162:163], v[162:163], v[114:115]
    v_pk_mul_f32 v[164:165], v[164:165], v[116:117]
    v_pk_mul_f32 v[166:167], v[166:167], v[118:119]
    v_cvt_pk_bf16_f32 v160, v160, v161
    v_cvt_pk_bf16_f32 v161, v162, v163
    v_add_u32 v162, v192, v64
    buffer_store_dwordx2 v[160:161], v162, s[48:51], 0 offen
    v_cvt_pk_bf16_f32 v164, v164, v165
    v_cvt_pk_bf16_f32 v165, v166, v167
    v_add_u32 v166, v192, v65
    buffer_store_dwordx2 v[164:165], v166, s[48:51], 0 offen
    s_lshl_b32 s28, s85, 4
    s_add_u32 s28, s28, s21
    s_lshr_b32 s28, s28, 2
    s_add_u32 s28, s28, 160
    v_add_u32 v192, s28, v19
    v_lshrrev_b32 v193, 3, v192
    v_lshlrev_b32 v193, 10, v193
    v_and_b32 v194, 3, v192
    v_lshl_add_u32 v193, v194, 8, v193
    v_bfe_u32 v194, v192, 2, 1
    v_lshl_add_u32 v192, v194, 3, v193
    v_lshlrev_b32 v88, 16, v230
    v_and_b32 v89, 0xffff0000, v230
    v_lshlrev_b32 v90, 16, v231
    v_and_b32 v91, 0xffff0000, v231
    v_pk_fma_f32 v[168:169], v[24:25], v[52:53], v[168:169] op_sel_hi:[0,1,1] neg_lo:[1,0,0] neg_hi:[1,0,0]
    v_pk_fma_f32 v[170:171], v[24:25], v[54:55], v[170:171] op_sel_hi:[0,1,1] neg_lo:[1,0,0] neg_hi:[1,0,0]
    v_pk_fma_f32 v[172:173], v[26:27], v[52:53], v[172:173] op_sel_hi:[0,1,1] neg_lo:[1,0,0] neg_hi:[1,0,0]
    v_pk_fma_f32 v[174:175], v[26:27], v[54:55], v[174:175] op_sel_hi:[0,1,1] neg_lo:[1,0,0] neg_hi:[1,0,0]
    v_pk_fma_f32 v[168:169], v[24:25], v[168:169], v[88:89] op_sel:[1,0,0] op_sel_hi:[1,1,1]
    v_pk_fma_f32 v[170:171], v[24:25], v[170:171], v[90:91] op_sel:[1,0,0] op_sel_hi:[1,1,1]
    v_pk_fma_f32 v[172:173], v[26:27], v[172:173], v[88:89] op_sel:[1,0,0] op_sel_hi:[1,1,1]
    v_pk_fma_f32 v[174:175], v[26:27], v[174:175], v[90:91] op_sel:[1,0,0] op_sel_hi:[1,1,1]
    v_pk_mul_f32 v[112:113], v[168:169], v[168:169]
    v_pk_mul_f32 v[114:115], v[170:171], v[170:171]
    v_pk_mul_f32 v[116:117], v[172:173], v[172:173]
    v_pk_mul_f32 v[118:119], v[174:175], v[174:175]
    v_pk_fma_f32 v[112:113], v[112:113], v[76:77], v[76:77] op_sel:[0,0,1] op_sel_hi:[1,0,1]
    v_pk_fma_f32 v[114:115], v[114:115], v[76:77], v[76:77] op_sel:[0,0,1] op_sel_hi:[1,0,1]
    v_pk_fma_f32 v[116:117], v[116:117], v[76:77], v[76:77] op_sel:[0,0,1] op_sel_hi:[1,0,1]
    v_pk_fma_f32 v[118:119], v[118:119], v[76:77], v[76:77] op_sel:[0,0,1] op_sel_hi:[1,0,1]
    v_pk_mul_f32 v[112:113], v[112:113], v[168:169]
    v_pk_mul_f32 v[114:115], v[114:115], v[170:171]
    v_pk_mul_f32 v[116:117], v[116:117], v[172:173]
    v_pk_mul_f32 v[118:119], v[118:119], v[174:175]
    v_exp_f32 v112, v112
    v_exp_f32 v113, v113
    v_exp_f32 v114, v114
    v_exp_f32 v115, v115
    v_exp_f32 v116, v116
    v_exp_f32 v117, v117
    v_exp_f32 v118, v118
    v_exp_f32 v119, v119
    v_pk_add_f32 v[112:113], v[112:113], v[78:79]
    v_pk_add_f32 v[114:115], v[114:115], v[78:79]
    v_pk_add_f32 v[116:117], v[116:117], v[78:79]
    v_pk_add_f32 v[118:119], v[118:119], v[78:79]
    v_rcp_f32 v112, v112
    v_rcp_f32 v113, v113
    v_rcp_f32 v114, v114
    v_rcp_f32 v115, v115
    v_rcp_f32 v116, v116
    v_rcp_f32 v117, v117
    v_rcp_f32 v118, v118
    v_rcp_f32 v119, v119
    v_pk_mul_f32 v[168:169], v[168:169], v[112:113]
    v_pk_mul_f32 v[170:171], v[170:171], v[114:115]
    v_pk_mul_f32 v[172:173], v[172:173], v[116:117]
    v_pk_mul_f32 v[174:175], v[174:175], v[118:119]
    v_cvt_pk_bf16_f32 v168, v168, v169
    v_cvt_pk_bf16_f32 v169, v170, v171
    v_add_u32 v170, v192, v64
    buffer_store_dwordx2 v[168:169], v170, s[48:51], 0 offen
    v_cvt_pk_bf16_f32 v172, v172, v173
    v_cvt_pk_bf16_f32 v173, v174, v175
    v_add_u32 v174, v192, v65
    buffer_store_dwordx2 v[172:173], v174, s[48:51], 0 offen
L_k1_fin:
L_k1_end:
    s_endpgm
.globl attn_kernel
.p2align 8
.type attn_kernel,@function
attn_kernel:
    s_cmp_ge_u32 s2, 256
    s_cbranch_scc1 L_k2_end
    s_load_dwordx2 s[4:5], s[0:1], 80
    v_and_b32 v1, 63, v0
    v_lshrrev_b32 v116, 6, v0
    s_nop 1
    v_readfirstlane_b32 s16, v116
    s_nop 3
    s_cmp_ge_u32 s16, 8
    s_cbranch_scc1 L_k2_mlp
    s_and_b32 s26, s2, 7
    s_lshr_b32 s27, s2, 3
    s_lshl_b32 s17, s26, 2
    s_and_b32 s28, s27, 3
    s_add_u32 s17, s17, s28
    s_lshr_b32 s18, s27, 2
    s_lshr_b32 s31, s16, 2
    v_lshlrev_b32 v2, 4, v1
    v_and_b32 v116, 31, v1
    v_lshrrev_b32 v117, 5, v1
    v_lshlrev_b32 v4, 3, v116
    v_lshl_add_u32 v3, v117, 9, v4
    v_lshl_add_u32 v4, v117, 8, v4
    v_add_u32 v4, 1024, v4
    v_bfe_u32 v118, v1, 2, 2
    v_lshl_add_u32 v118, v117, 2, v118
    v_bfe_u32 v119, v1, 4, 1
    v_and_b32 v120, 3, v1
    v_lshl_add_u32 v119, v119, 2, v120
    v_lshl_add_u32 v118, v119, 2, v118
    v_lshlrev_b32 v119, 8, v119
    v_and_b32 v120, 31, v118
    v_lshl_add_u32 v128, v120, 3, v119
    v_add_u32 v120, 8, v118
    v_and_b32 v120, 31, v120
    v_lshl_add_u32 v129, v120, 3, v119
    v_add_u32 v120, 16, v118
    v_and_b32 v120, 31, v120
    v_lshl_add_u32 v130, v120, 3, v119
    v_add_u32 v120, 24, v118
    v_and_b32 v120, 31, v120
    v_lshl_add_u32 v131, v120, 3, v119
    s_waitcnt lgkmcnt(0)
    s_mov_b32 s8, s4
    s_mov_b32 s9, s5
    s_mov_b32 s10, 9437184
    s_mov_b32 s11, 0x00020000
    s_add_u32 s12, s4, 9437184
    s_addc_u32 s13, s5, 0
    s_mov_b32 s14, 8912896
    s_mov_b32 s15, 0x00020000
    s_mul_i32 s24, s17, 98304
    s_lshl_b32 s26, s18, 2
    s_and_b32 s27, s16, 3
    s_add_u32 s26, s26, s27
    s_mul_i32 s26, s26, 3072
    s_add_u32 s24, s24, s26
    buffer_load_dwordx2 v[12:13], v3, s[8:11], s24 offen
    buffer_load_dwordx2 v[14:15], v3, s[8:11], s24 offen offset:256
    buffer_load_dwordx2 v[16:17], v4, s[8:11], s24 offen
    buffer_load_dwordx2 v[20:21], v3, s[8:11], s24 offen offset:1536
    buffer_load_dwordx2 v[22:23], v3, s[8:11], s24 offen offset:1792
    buffer_load_dwordx2 v[24:25], v4, s[8:11], s24 offen offset:1536
    s_add_u32 s26, s17, 32
    s_mul_i32 s25, s26, 98304
    s_lshr_b32 s26, s16, 2
    s_mul_i32 s26, s26, 3145728
    s_add_u32 s20, s25, s26
    s_bfe_u32 s26, s16, 0x10001
    s_mul_i32 s26, s26, 49152
    s_add_u32 s20, s20, s26
    s_and_b32 s26, s16, 1
    s_mul_i32 s26, s26, 3072
    s_add_u32 s20, s20, s26
    s_mov_b32 s23, 0
    s_mov_b32 s30, 0x07060302
    s_mul_i32 s26, s16, 3072
    s_add_u32 s26, s26, 0
    s_mov_b32 m0, s26
    s_mul_i32 s27, 0, 6144
    s_add_u32 s27, s27, s20
    buffer_load_dwordx4 v2, s[8:11], s27 offen lds
    buffer_load_dwordx4 v2, s[8:11], s27 offen offset:1024 lds
    buffer_load_dwordx4 v2, s[8:11], s27 offen offset:2048 lds
    s_mul_i32 s26, s16, 3072
    s_add_u32 s26, s26, 24576
    s_mov_b32 m0, s26
    s_mul_i32 s27, 1, 6144
    s_add_u32 s27, s27, s20
    buffer_load_dwordx4 v2, s[8:11], s27 offen lds
    buffer_load_dwordx4 v2, s[8:11], s27 offen offset:1024 lds
    buffer_load_dwordx4 v2, s[8:11], s27 offen offset:2048 lds
    v_mov_b32 v84, 0
    v_mov_b32 v85, 0
    v_mov_b32 v86, 0
    v_mov_b32 v87, 0
    v_mov_b32 v88, 0
    v_mov_b32 v89, 0
    v_mov_b32 v90, 0
    v_mov_b32 v91, 0
    v_mov_b32 v92, 0
    v_mov_b32 v93, 0
    v_mov_b32 v94, 0
    v_mov_b32 v95, 0
    v_mov_b32 v96, 0
    v_mov_b32 v97, 0
    v_mov_b32 v98, 0
    v_mov_b32 v99, 0
    v_mov_b32 v100, 0
    v_mov_b32 v101, 0
    v_mov_b32 v102, 0
    v_mov_b32 v103, 0
    v_mov_b32 v104, 0
    v_mov_b32 v105, 0
    v_mov_b32 v106, 0
    v_mov_b32 v107, 0
    v_mov_b32 v108, 0
    v_mov_b32 v109, 0
    v_mov_b32 v110, 0
    v_mov_b32 v111, 0
    v_mov_b32 v112, 0
    v_mov_b32 v113, 0
    v_mov_b32 v114, 0
    v_mov_b32 v115, 0
    s_mul_i32 s26, s31, 6144
    v_add_u32 v5, s26, v3
    v_add_u32 v6, s26, v4
    s_add_u32 s27, s26, 12288
    v_add_u32 v132, s27, v128
    v_add_u32 v133, s27, v129
    v_add_u32 v134, s27, v130
    v_add_u32 v135, s27, v131
    v_add_u32 v7, 24576, v5
    v_add_u32 v8, 24576, v6
    v_add_u32 v136, 24576, v132
    v_add_u32 v137, 24576, v133
    v_add_u32 v138, 24576, v134
    v_add_u32 v139, 24576, v135
    v_mov_b32 v34, 0
    v_mov_b32 v35, 0
    s_mov_b32 s21, 24576
    s_mov_b32 s22, 49152
    s_mov_b32 s19, 0
    s_waitcnt vmcnt(6)
    v_cmp_gt_u32 vcc, 32, v1
    v_mov_b32 v18, 0
    v_mov_b32 v19, 0
    v_cndmask_b32 v16, 0, v16, vcc
    v_cndmask_b32 v17, 0, v17, vcc
    v_mov_b32 v26, 0
    v_mov_b32 v27, 0
    v_cndmask_b32 v24, 0, v24, vcc
    v_cndmask_b32 v25, 0, v25, vcc
    s_waitcnt vmcnt(3)
    s_barrier
    ds_read_b64 v[28:29], v3 offset:0
    ds_read_b64 v[30:31], v3 offset:256
    ds_read_b64 v[32:33], v4 offset:0
    s_waitcnt lgkmcnt(0)
    v_mfma_f32_32x32x16_bf16 v[52:67], v[28:31], v[12:15], 0
    v_mfma_f32_32x32x16_bf16 v[52:67], v[32:35], v[16:19], v[52:67]
    v_mfma_f32_32x32x16_bf16 v[68:83], v[28:31], v[20:23], 0
    v_mfma_f32_32x32x16_bf16 v[68:83], v[32:35], v[24:27], v[68:83]
    ds_read_b64 v[28:29], v5 offset:0
    ds_read_b64 v[30:31], v5 offset:256
    ds_read_b64 v[32:33], v6 offset:0
    s_nop 15
    v_max3_f32 v116, v52, v53, v54
    v_max3_f32 v116, v116, v55, v56
    v_max3_f32 v116, v116, v57, v58
    v_max3_f32 v116, v116, v59, v60
    v_max3_f32 v116, v116, v61, v62
    v_max3_f32 v116, v116, v63, v64
    v_max3_f32 v116, v116, v65, v66
    v_max_f32 v116, v116, v67
    v_mov_b32 v117, v116
    s_nop 1
    v_permlane32_swap_b32 v116, v117
    s_nop 1
    v_max_f32 v116, v116, v117
    v_sub_f32 v116, 0, v116
    v_and_b32 v117, 0xffff0000, v116
    v_sub_f32 v118, v116, v117
    v_perm_b32 v118, v118, v117, s30
    v_cmp_gt_u32 vcc, 32, v1
    s_nop 1
    v_cndmask_b32 v16, v118, v16, vcc
    v_max3_f32 v116, v68, v69, v70
    v_max3_f32 v116, v116, v71, v72
    v_max3_f32 v116, v116, v73, v74
    v_max3_f32 v116, v116, v75, v76
    v_max3_f32 v116, v116, v77, v78
    v_max3_f32 v116, v116, v79, v80
    v_max3_f32 v116, v116, v81, v82
    v_max_f32 v116, v116, v83
    v_mov_b32 v117, v116
    s_nop 1
    v_permlane32_swap_b32 v116, v117
    s_nop 1
    v_max_f32 v116, v116, v117
    v_sub_f32 v116, 0, v116
    v_and_b32 v117, 0xffff0000, v116
    v_sub_f32 v118, v116, v117
    v_perm_b32 v118, v118, v117, s30
    v_cmp_gt_u32 vcc, 32, v1
    s_nop 1
    v_cndmask_b32 v24, v118, v24, vcc
    s_waitcnt lgkmcnt(0)
    s_nop 1
    v_mfma_f32_32x32x16_bf16 v[52:67], v[28:31], v[12:15], 0
    v_mfma_f32_32x32x16_bf16 v[52:67], v[32:35], v[16:19], v[52:67]
    ds_read_b64_tr_b16 v[40:41], v134 offset:0
    ds_read_b64_tr_b16 v[42:43], v135 offset:0
    ds_read_b64_tr_b16 v[36:37], v132 offset:0
    ds_read_b64_tr_b16 v[38:39], v133 offset:0
    v_mov_b32 v48, 0
    v_mov_b32 v49, 0
    v_mov_b32 v50, 0
    v_mov_b32 v51, 0
    v_mov_b32 v140, 0
    v_mov_b32 v141, 0
    v_mov_b32 v142, 0
    v_mov_b32 v143, 0
    s_nop 7
L_k2_loop:
    v_mfma_f32_32x32x16_bf16 v[68:83], v[28:31], v[20:23], 0
    v_exp_f32 v52, v52
    v_exp_f32 v53, v53
    v_cvt_pk_bf16_f32 v50, v140, v141
    v_cvt_pk_bf16_f32 v51, v142, v143
    v_exp_f32 v54, v54
    v_exp_f32 v55, v55
    v_mfma_f32_32x32x16_bf16 v[68:83], v[32:35], v[24:27], v[68:83]
    ds_read_b64 v[28:29], v5 offset:1536
    ds_read_b64 v[30:31], v5 offset:1792
    ds_read_b64 v[32:33], v6 offset:1536
    v_exp_f32 v56, v56
    v_exp_f32 v57, v57
    v_cvt_pk_bf16_f32 v44, v52, v53
    v_cvt_pk_bf16_f32 v45, v54, v55
    v_exp_f32 v58, v58
    v_exp_f32 v59, v59
    s_waitcnt lgkmcnt(5)
    v_mfma_f32_32x32x16_bf16 v[100:115], v[40:43], v[48:51], v[100:115]
    ds_read_b64_tr_b16 v[40:41], v134 offset:0
    ds_read_b64_tr_b16 v[42:43], v135 offset:0
    v_exp_f32 v60, v60
    v_exp_f32 v61, v61
    v_cvt_pk_bf16_f32 v46, v56, v57
    v_cvt_pk_bf16_f32 v47, v58, v59
    v_exp_f32 v62, v62
    v_exp_f32 v63, v63
    s_waitcnt lgkmcnt(5)
    v_mfma_f32_32x32x16_bf16 v[84:99], v[36:39], v[44:47], v[84:99]
    v_exp_f32 v140, v64
    v_exp_f32 v141, v65
    v_cvt_pk_bf16_f32 v48, v60, v61
    v_cvt_pk_bf16_f32 v49, v62, v63
    v_exp_f32 v142, v66
    v_exp_f32 v143, v67
    s_waitcnt lgkmcnt(2)
    v_mfma_f32_32x32x16_bf16 v[52:67], v[28:31], v[12:15], 0
    v_exp_f32 v68, v68
    v_exp_f32 v69, v69
    v_cvt_pk_bf16_f32 v50, v140, v141
    v_cvt_pk_bf16_f32 v51, v142, v143
    v_exp_f32 v70, v70
    v_exp_f32 v71, v71
    v_mfma_f32_32x32x16_bf16 v[52:67], v[32:35], v[16:19], v[52:67]
    v_exp_f32 v72, v72
    v_exp_f32 v73, v73
    v_cvt_pk_bf16_f32 v44, v68, v69
    v_cvt_pk_bf16_f32 v45, v70, v71
    v_exp_f32 v74, v74
    v_exp_f32 v75, v75
    s_waitcnt lgkmcnt(0)
    v_mfma_f32_32x32x16_bf16 v[84:99], v[40:43], v[48:51], v[84:99]
    v_exp_f32 v76, v76
    v_exp_f32 v77, v77
    v_cvt_pk_bf16_f32 v46, v72, v73
    v_cvt_pk_bf16_f32 v47, v74, v75
    v_exp_f32 v78, v78
    v_exp_f32 v79, v79
    v_mfma_f32_32x32x16_bf16 v[100:115], v[36:39], v[44:47], v[100:115]
    ds_read_b64_tr_b16 v[36:37], v132 offset:1536
    ds_read_b64_tr_b16 v[38:39], v133 offset:1536
    v_exp_f32 v140, v80
    v_exp_f32 v141, v81
    v_cvt_pk_bf16_f32 v48, v76, v77
    v_cvt_pk_bf16_f32 v49, v78, v79
    v_exp_f32 v142, v82
    v_exp_f32 v143, v83
    v_mfma_f32_32x32x16_bf16 v[68:83], v[28:31], v[20:23], 0
    v_exp_f32 v52, v52
    v_exp_f32 v53, v53
    v_cvt_pk_bf16_f32 v50, v140, v141
    v_cvt_pk_bf16_f32 v51, v142, v143
    v_exp_f32 v54, v54
    v_exp_f32 v55, v55
    v_mfma_f32_32x32x16_bf16 v[68:83], v[32:35], v[24:27], v[68:83]
    ds_read_b64 v[28:29], v5 offset:3072
    ds_read_b64 v[30:31], v5 offset:3328
    ds_read_b64 v[32:33], v6 offset:3072
    v_exp_f32 v56, v56
    v_exp_f32 v57, v57
    v_cvt_pk_bf16_f32 v44, v52, v53
    v_cvt_pk_bf16_f32 v45, v54, v55
    v_exp_f32 v58, v58
    v_exp_f32 v59, v59
    s_waitcnt lgkmcnt(5)
    v_mfma_f32_32x32x16_bf16 v[100:115], v[40:43], v[48:51], v[100:115]
    ds_read_b64_tr_b16 v[40:41], v134 offset:1536
    ds_read_b64_tr_b16 v[42:43], v135 offset:1536
    v_exp_f32 v60, v60
    v_exp_f32 v61, v61
    v_cvt_pk_bf16_f32 v46, v56, v57
    v_cvt_pk_bf16_f32 v47, v58, v59
    v_exp_f32 v62, v62
    v_exp_f32 v63, v63
    s_waitcnt lgkmcnt(5)
    v_mfma_f32_32x32x16_bf16 v[84:99], v[36:39], v[44:47], v[84:99]
    v_exp_f32 v140, v64
    v_exp_f32 v141, v65
    v_cvt_pk_bf16_f32 v48, v60, v61
    v_cvt_pk_bf16_f32 v49, v62, v63
    v_exp_f32 v142, v66
    v_exp_f32 v143, v67
    s_waitcnt lgkmcnt(2)
    v_mfma_f32_32x32x16_bf16 v[52:67], v[28:31], v[12:15], 0
    v_exp_f32 v68, v68
    v_exp_f32 v69, v69
    v_cvt_pk_bf16_f32 v50, v140, v141
    v_cvt_pk_bf16_f32 v51, v142, v143
    v_exp_f32 v70, v70
    v_exp_f32 v71, v71
    v_mfma_f32_32x32x16_bf16 v[52:67], v[32:35], v[16:19], v[52:67]
    v_exp_f32 v72, v72
    v_exp_f32 v73, v73
    v_cvt_pk_bf16_f32 v44, v68, v69
    v_cvt_pk_bf16_f32 v45, v70, v71
    v_exp_f32 v74, v74
    v_exp_f32 v75, v75
    s_waitcnt lgkmcnt(0)
    v_mfma_f32_32x32x16_bf16 v[84:99], v[40:43], v[48:51], v[84:99]
    v_exp_f32 v76, v76
    v_exp_f32 v77, v77
    v_cvt_pk_bf16_f32 v46, v72, v73
    v_cvt_pk_bf16_f32 v47, v74, v75
    v_exp_f32 v78, v78
    v_exp_f32 v79, v79
    v_mfma_f32_32x32x16_bf16 v[100:115], v[36:39], v[44:47], v[100:115]
    ds_read_b64_tr_b16 v[36:37], v132 offset:3072
    ds_read_b64_tr_b16 v[38:39], v133 offset:3072
    v_exp_f32 v140, v80
    v_exp_f32 v141, v81
    v_cvt_pk_bf16_f32 v48, v76, v77
    v_cvt_pk_bf16_f32 v49, v78, v79
    v_exp_f32 v142, v82
    v_exp_f32 v143, v83
    v_mfma_f32_32x32x16_bf16 v[68:83], v[28:31], v[20:23], 0
    v_exp_f32 v52, v52
    v_exp_f32 v53, v53
    v_cvt_pk_bf16_f32 v50, v140, v141
    v_cvt_pk_bf16_f32 v51, v142, v143
    v_exp_f32 v54, v54
    v_exp_f32 v55, v55
    v_mfma_f32_32x32x16_bf16 v[68:83], v[32:35], v[24:27], v[68:83]
    ds_read_b64 v[28:29], v5 offset:4608
    ds_read_b64 v[30:31], v5 offset:4864
    ds_read_b64 v[32:33], v6 offset:4608
    v_exp_f32 v56, v56
    v_exp_f32 v57, v57
    v_cvt_pk_bf16_f32 v44, v52, v53
    v_cvt_pk_bf16_f32 v45, v54, v55
    v_exp_f32 v58, v58
    v_exp_f32 v59, v59
    s_waitcnt lgkmcnt(5)
    v_mfma_f32_32x32x16_bf16 v[100:115], v[40:43], v[48:51], v[100:115]
    ds_read_b64_tr_b16 v[40:41], v134 offset:3072
    ds_read_b64_tr_b16 v[42:43], v135 offset:3072
    v_exp_f32 v60, v60
    v_exp_f32 v61, v61
    v_cvt_pk_bf16_f32 v46, v56, v57
    v_cvt_pk_bf16_f32 v47, v58, v59
    v_exp_f32 v62, v62
    v_exp_f32 v63, v63
    s_waitcnt lgkmcnt(5)
    v_mfma_f32_32x32x16_bf16 v[84:99], v[36:39], v[44:47], v[84:99]
    v_exp_f32 v140, v64
    v_exp_f32 v141, v65
    v_cvt_pk_bf16_f32 v48, v60, v61
    v_cvt_pk_bf16_f32 v49, v62, v63
    v_exp_f32 v142, v66
    v_exp_f32 v143, v67
    s_waitcnt lgkmcnt(2)
    v_mfma_f32_32x32x16_bf16 v[52:67], v[28:31], v[12:15], 0
    v_exp_f32 v68, v68
    v_exp_f32 v69, v69
    v_cvt_pk_bf16_f32 v50, v140, v141
    v_cvt_pk_bf16_f32 v51, v142, v143
    v_exp_f32 v70, v70
    v_exp_f32 v71, v71
    v_mfma_f32_32x32x16_bf16 v[52:67], v[32:35], v[16:19], v[52:67]
    v_exp_f32 v72, v72
    v_exp_f32 v73, v73
    v_cvt_pk_bf16_f32 v44, v68, v69
    v_cvt_pk_bf16_f32 v45, v70, v71
    v_exp_f32 v74, v74
    v_exp_f32 v75, v75
    s_waitcnt lgkmcnt(0)
    v_mfma_f32_32x32x16_bf16 v[84:99], v[40:43], v[48:51], v[84:99]
    v_exp_f32 v76, v76
    v_exp_f32 v77, v77
    v_cvt_pk_bf16_f32 v46, v72, v73
    v_cvt_pk_bf16_f32 v47, v74, v75
    v_exp_f32 v78, v78
    v_exp_f32 v79, v79
    v_mfma_f32_32x32x16_bf16 v[100:115], v[36:39], v[44:47], v[100:115]
    ds_read_b64_tr_b16 v[36:37], v132 offset:4608
    ds_read_b64_tr_b16 v[38:39], v133 offset:4608
    v_exp_f32 v140, v80
    v_exp_f32 v141, v81
    v_cvt_pk_bf16_f32 v48, v76, v77
    v_cvt_pk_bf16_f32 v49, v78, v79
    v_exp_f32 v142, v82
    v_exp_f32 v143, v83
    v_mfma_f32_32x32x16_bf16 v[68:83], v[28:31], v[20:23], 0
    v_exp_f32 v52, v52
    v_exp_f32 v53, v53
    v_cvt_pk_bf16_f32 v50, v140, v141
    v_cvt_pk_bf16_f32 v51, v142, v143
    v_exp_f32 v54, v54
    v_exp_f32 v55, v55
    v_mfma_f32_32x32x16_bf16 v[68:83], v[32:35], v[24:27], v[68:83]
    s_waitcnt vmcnt(0)
    s_barrier
    s_add_u32 s28, s19, 2
    s_cmp_ge_u32 s28, 8
    s_cbranch_scc1 L_k2_nodma
    s_mul_i32 s26, s16, 3072
    s_add_u32 s26, s26, s22
    s_mov_b32 m0, s26
    s_mul_i32 s27, s28, 6144
    s_add_u32 s27, s27, s20
    buffer_load_dwordx4 v2, s[8:11], s27 offen lds
    buffer_load_dwordx4 v2, s[8:11], s27 offen offset:1024 lds
    buffer_load_dwordx4 v2, s[8:11], s27 offen offset:2048 lds
L_k2_nodma:
    ds_read_b64 v[28:29], v7 offset:0
    ds_read_b64 v[30:31], v7 offset:256
    ds_read_b64 v[32:33], v8 offset:0
    v_exp_f32 v56, v56
    v_exp_f32 v57, v57
    v_cvt_pk_bf16_f32 v44, v52, v53
    v_cvt_pk_bf16_f32 v45, v54, v55
    v_exp_f32 v58, v58
    v_exp_f32 v59, v59
    s_waitcnt lgkmcnt(5)
    v_mfma_f32_32x32x16_bf16 v[100:115], v[40:43], v[48:51], v[100:115]
    ds_read_b64_tr_b16 v[40:41], v134 offset:4608
    ds_read_b64_tr_b16 v[42:43], v135 offset:4608
    v_exp_f32 v60, v60
    v_exp_f32 v61, v61
    v_cvt_pk_bf16_f32 v46, v56, v57
    v_cvt_pk_bf16_f32 v47, v58, v59
    v_exp_f32 v62, v62
    v_exp_f32 v63, v63
    s_waitcnt lgkmcnt(5)
    v_mfma_f32_32x32x16_bf16 v[84:99], v[36:39], v[44:47], v[84:99]
    v_exp_f32 v140, v64
    v_exp_f32 v141, v65
    v_cvt_pk_bf16_f32 v48, v60, v61
    v_cvt_pk_bf16_f32 v49, v62, v63
    v_exp_f32 v142, v66
    v_exp_f32 v143, v67
    s_waitcnt lgkmcnt(2)
    v_mfma_f32_32x32x16_bf16 v[52:67], v[28:31], v[12:15], 0
    v_exp_f32 v68, v68
    v_exp_f32 v69, v69
    v_cvt_pk_bf16_f32 v50, v140, v141
    v_cvt_pk_bf16_f32 v51, v142, v143
    v_exp_f32 v70, v70
    v_exp_f32 v71, v71
    v_mfma_f32_32x32x16_bf16 v[52:67], v[32:35], v[16:19], v[52:67]
    v_exp_f32 v72, v72
    v_exp_f32 v73, v73
    v_cvt_pk_bf16_f32 v44, v68, v69
    v_cvt_pk_bf16_f32 v45, v70, v71
    v_exp_f32 v74, v74
    v_exp_f32 v75, v75
    s_waitcnt lgkmcnt(0)
    v_mfma_f32_32x32x16_bf16 v[84:99], v[40:43], v[48:51], v[84:99]
    v_exp_f32 v76, v76
    v_exp_f32 v77, v77
    v_cvt_pk_bf16_f32 v46, v72, v73
    v_cvt_pk_bf16_f32 v47, v74, v75
    v_exp_f32 v78, v78
    v_exp_f32 v79, v79
    v_mfma_f32_32x32x16_bf16 v[100:115], v[36:39], v[44:47], v[100:115]
    ds_read_b64_tr_b16 v[36:37], v136 offset:0
    ds_read_b64_tr_b16 v[38:39], v137 offset:0
    v_exp_f32 v140, v80
    v_exp_f32 v141, v81
    v_cvt_pk_bf16_f32 v48, v76, v77
    v_cvt_pk_bf16_f32 v49, v78, v79
    v_exp_f32 v142, v82
    v_exp_f32 v143, v83
    v_mov_b32 v5, v7
    v_mov_b32 v6, v8
    v_mov_b32 v132, v136
    v_mov_b32 v133, v137
    v_mov_b32 v134, v138
    v_mov_b32 v135, v139
    s_mov_b32 s21, s22
    s_add_u32 s22, s22, 24576
    s_cmp_ge_u32 s22, 73728
    s_cselect_b32 s22, 0, s22
    s_mul_i32 s26, s31, 6144
    s_add_u32 s26, s26, s21
    v_add_u32 v7, s26, v3
    v_add_u32 v8, s26, v4
    s_add_u32 s26, s26, 12288
    v_add_u32 v136, s26, v128
    v_add_u32 v137, s26, v129
    v_add_u32 v138, s26, v130
    v_add_u32 v139, s26, v131
    s_add_u32 s19, s19, 1
    s_cmp_lt_u32 s19, 8
    s_cbranch_scc1 L_k2_loop
    v_cvt_pk_bf16_f32 v50, v140, v141
    v_cvt_pk_bf16_f32 v51, v142, v143
    s_waitcnt lgkmcnt(0)
    s_nop 0
    v_mfma_f32_32x32x16_bf16 v[100:115], v[40:43], v[48:51], v[100:115]
    s_mul_i32 s26, s16, 3072
    s_add_u32 s26, s26, 0
    v_add_u32 v116, s26, v2
    s_xor_b32 s27, s16, 4
    s_mul_i32 s27, s27, 3072
    s_add_u32 s27, s27, 0
    v_add_u32 v117, s27, v2
    s_nop 15
    s_cmp_eq_u32 s31, 0
    s_cbranch_scc1 L_k2_h0
    ds_write_b128 v116, v[84:87] offset:0
    ds_write_b128 v116, v[88:91] offset:1024
    ds_write_b128 v116, v[92:95] offset:2048
    s_waitcnt lgkmcnt(0)
    v_mov_b32 v84, v100
    v_mov_b32 v85, v101
    v_mov_b32 v86, v102
    v_mov_b32 v87, v103
    v_mov_b32 v88, v104
    v_mov_b32 v89, v105
    v_mov_b32 v90, v106
    v_mov_b32 v91, v107
    v_mov_b32 v92, v108
    v_mov_b32 v93, v109
    v_mov_b32 v94, v110
    v_mov_b32 v95, v111
    v_mov_b32 v12, v20
    v_mov_b32 v13, v21
    v_mov_b32 v14, v22
    v_mov_b32 v15, v23
    v_mov_b32 v16, v24
    v_mov_b32 v17, v25
    v_mov_b32 v18, v26
    v_mov_b32 v19, v27
    s_branch L_k2_merge
L_k2_h0:
    ds_write_b128 v116, v[100:103] offset:0
    ds_write_b128 v116, v[104:107] offset:1024
    ds_write_b128 v116, v[108:111] offset:2048
    s_waitcnt lgkmcnt(0)
L_k2_merge:
    s_barrier
    ds_read_b128 v[100:103], v117 offset:0
    ds_read_b128 v[104:107], v117 offset:1024
    ds_read_b128 v[108:111], v117 offset:2048
    s_waitcnt lgkmcnt(0)
    v_add_f32 v84, v84, v100
    v_add_f32 v85, v85, v101
    v_add_f32 v86, v86, v102
    v_add_f32 v87, v87, v103
    v_add_f32 v88, v88, v104
    v_add_f32 v89, v89, v105
    v_add_f32 v90, v90, v106
    v_add_f32 v91, v91, v107
    v_add_f32 v92, v92, v108
    v_add_f32 v93, v93, v109
    v_add_f32 v94, v94, v110
    v_add_f32 v95, v95, v111
L_k2_getl:
    v_mov_b32 v116, v92
    v_mov_b32 v117, v92
    s_nop 1
    v_permlane32_swap_b32 v116, v117
    s_nop 1
    s_cmp_lg_u32 s23, 0
    s_cbranch_scc1 L_k2_store
    v_mov_b32 v118, 0x5f800000
    v_cmp_nle_f32 vcc, v117, v118
    s_cmp_eq_u64 vcc, 0
    s_cbranch_scc1 L_k2_store
    s_mov_b32 s23, 1
    v_cmp_gt_u32 vcc, 32, v1
    s_nop 1
    v_cndmask_b32 v16, 0, v16, vcc
    v_mov_b32 v116, 0xff800000
    s_mov_b32 s26, 0
L_k2_maxloop:
    s_mul_i32 s27, s26, 1536
    s_add_u32 s27, s27, s25
    buffer_load_dwordx2 v[28:29], v3, s[8:11], s27 offen
    buffer_load_dwordx2 v[30:31], v3, s[8:11], s27 offen offset:256
    buffer_load_dwordx2 v[32:33], v4, s[8:11], s27 offen
    s_waitcnt vmcnt(0)
    v_mfma_f32_32x32x16_bf16 v[52:67], v[28:31], v[12:15], 0
    v_mfma_f32_32x32x16_bf16 v[52:67], v[32:35], v[16:19], v[52:67]
    s_nop 15
    s_nop 3
    v_max3_f32 v116, v116, v52, v53
    v_max3_f32 v116, v116, v54, v55
    v_max3_f32 v116, v116, v56, v57
    v_max3_f32 v116, v116, v58, v59
    v_max3_f32 v116, v116, v60, v61
    v_max3_f32 v116, v116, v62, v63
    v_max3_f32 v116, v116, v64, v65
    v_max3_f32 v116, v116, v66, v67
    s_add_u32 s26, s26, 1
    s_cmp_lt_u32 s26, 64
    s_cbranch_scc1 L_k2_maxloop
    v_mov_b32 v117, v116
    s_nop 1
    v_permlane32_swap_b32 v116, v117
    s_nop 1
    v_max_f32 v116, v116, v117
    v_sub_f32 v116, 0, v116
    v_and_b32 v117, 0xffff0000, v116
    v_sub_f32 v118, v116, v117
    v_perm_b32 v118, v118, v117, s30
    v_cmp_gt_u32 vcc, 32, v1
    s_nop 1
    v_cndmask_b32 v16, v118, v16, vcc
    v_mov_b32 v84, 0
    v_mov_b32 v85, 0
    v_mov_b32 v86, 0
    v_mov_b32 v87, 0
    v_mov_b32 v88, 0
    v_mov_b32 v89, 0
    v_mov_b32 v90, 0
    v_mov_b32 v91, 0
    v_mov_b32 v92, 0
    v_mov_b32 v93, 0
    v_mov_b32 v94, 0
    v_mov_b32 v95, 0
    v_mov_b32 v96, 0
    v_mov_b32 v97, 0
    v_mov_b32 v98, 0
    v_mov_b32 v99, 0
    s_xor_b32 s28, s16, 4
    s_mul_i32 s28, s28, 3072
    s_add_u32 s28, s28, 0
    v_add_u32 v132, s28, v128
    v_add_u32 v133, s28, v129
    v_add_u32 v134, s28, v130
    v_add_u32 v135, s28, v131
    s_mov_b32 s26, 0
L_k2_slowloop:
    s_mov_b32 m0, s28
    s_mul_i32 s27, s26, 3072
    s_add_u32 s27, s27, s25
    s_add_u32 s29, s27, 3145728
    buffer_load_dwordx4 v2, s[8:11], s29 offen lds
    buffer_load_dwordx4 v2, s[8:11], s29 offen offset:1024 lds
    buffer_load_dwordx4 v2, s[8:11], s29 offen offset:2048 lds
    buffer_load_dwordx2 v[28:29], v3, s[8:11], s27 offen offset:0
    buffer_load_dwordx2 v[30:31], v3, s[8:11], s27 offen offset:256
    buffer_load_dwordx2 v[32:33], v4, s[8:11], s27 offen offset:0
    s_waitcnt vmcnt(0)
    v_mfma_f32_32x32x16_bf16 v[52:67], v[28:31], v[12:15], 0
    v_mfma_f32_32x32x16_bf16 v[52:67], v[32:35], v[16:19], v[52:67]
    ds_read_b64_tr_b16 v[36:37], v132 offset:0
    ds_read_b64_tr_b16 v[38:39], v133 offset:0
    ds_read_b64_tr_b16 v[40:41], v134 offset:0
    ds_read_b64_tr_b16 v[42:43], v135 offset:0
    s_nop 15
    v_exp_f32 v52, v52
    v_exp_f32 v53, v53
    v_exp_f32 v54, v54
    v_exp_f32 v55, v55
    v_exp_f32 v56, v56
    v_exp_f32 v57, v57
    v_exp_f32 v58, v58
    v_exp_f32 v59, v59
    v_exp_f32 v60, v60
    v_exp_f32 v61, v61
    v_exp_f32 v62, v62
    v_exp_f32 v63, v63
    v_exp_f32 v64, v64
    v_exp_f32 v65, v65
    v_exp_f32 v66, v66
    v_exp_f32 v67, v67
    s_nop 0
    v_cvt_pk_bf16_f32 v44, v52, v53
    v_cvt_pk_bf16_f32 v45, v54, v55
    v_cvt_pk_bf16_f32 v46, v56, v57
    v_cvt_pk_bf16_f32 v47, v58, v59
    v_cvt_pk_bf16_f32 v48, v60, v61
    v_cvt_pk_bf16_f32 v49, v62, v63
    v_cvt_pk_bf16_f32 v50, v64, v65
    v_cvt_pk_bf16_f32 v51, v66, v67
    s_waitcnt lgkmcnt(0)
    s_nop 1
    v_mfma_f32_32x32x16_bf16 v[84:99], v[36:39], v[44:47], v[84:99]
    v_mfma_f32_32x32x16_bf16 v[84:99], v[40:43], v[48:51], v[84:99]
    s_nop 7
    buffer_load_dwordx2 v[28:29], v3, s[8:11], s27 offen offset:1536
    buffer_load_dwordx2 v[30:31], v3, s[8:11], s27 offen offset:1792
    buffer_load_dwordx2 v[32:33], v4, s[8:11], s27 offen offset:1536
    s_waitcnt vmcnt(0)
    v_mfma_f32_32x32x16_bf16 v[52:67], v[28:31], v[12:15], 0
    v_mfma_f32_32x32x16_bf16 v[52:67], v[32:35], v[16:19], v[52:67]
    ds_read_b64_tr_b16 v[36:37], v132 offset:1536
    ds_read_b64_tr_b16 v[38:39], v133 offset:1536
    ds_read_b64_tr_b16 v[40:41], v134 offset:1536
    ds_read_b64_tr_b16 v[42:43], v135 offset:1536
    s_nop 15
    v_exp_f32 v52, v52
    v_exp_f32 v53, v53
    v_exp_f32 v54, v54
    v_exp_f32 v55, v55
    v_exp_f32 v56, v56
    v_exp_f32 v57, v57
    v_exp_f32 v58, v58
    v_exp_f32 v59, v59
    v_exp_f32 v60, v60
    v_exp_f32 v61, v61
    v_exp_f32 v62, v62
    v_exp_f32 v63, v63
    v_exp_f32 v64, v64
    v_exp_f32 v65, v65
    v_exp_f32 v66, v66
    v_exp_f32 v67, v67
    s_nop 0
    v_cvt_pk_bf16_f32 v44, v52, v53
    v_cvt_pk_bf16_f32 v45, v54, v55
    v_cvt_pk_bf16_f32 v46, v56, v57
    v_cvt_pk_bf16_f32 v47, v58, v59
    v_cvt_pk_bf16_f32 v48, v60, v61
    v_cvt_pk_bf16_f32 v49, v62, v63
    v_cvt_pk_bf16_f32 v50, v64, v65
    v_cvt_pk_bf16_f32 v51, v66, v67
    s_waitcnt lgkmcnt(0)
    s_nop 1
    v_mfma_f32_32x32x16_bf16 v[84:99], v[36:39], v[44:47], v[84:99]
    v_mfma_f32_32x32x16_bf16 v[84:99], v[40:43], v[48:51], v[84:99]
    s_nop 7
    s_add_u32 s26, s26, 1
    s_cmp_lt_u32 s26, 32
    s_cbranch_scc1 L_k2_slowloop
    s_nop 15
    s_branch L_k2_getl
L_k2_store:
    v_rcp_f32 v117, v117
    s_lshl_b32 s26, s18, 3
    s_and_b32 s27, s16, 3
    s_lshl_b32 s27, s27, 1
    s_add_u32 s26, s26, s27
    s_add_u32 s26, s26, s31
    s_lshl_b32 s26, s26, 5
    v_and_b32 v118, 31, v1
    v_add_u32 v118, s26, v118
    v_lshrrev_b32 v119, 4, v118
    v_mul_u32_u24 v119, 69632, v119
    v_and_b32 v118, 15, v118
    v_lshl_add_u32 v118, v118, 4, v119
    v_lshrrev_b32 v119, 5, v1
    s_mul_i32 s27, s17, 5
    v_add_u32 v119, s27, v119
    v_mul_f32 v84, v84, v117
    v_mul_f32 v85, v85, v117
    v_mul_f32 v86, v86, v117
    v_mul_f32 v87, v87, v117
    v_mul_f32 v88, v88, v117
    v_mul_f32 v89, v89, v117
    v_mul_f32 v90, v90, v117
    v_mul_f32 v91, v91, v117
    v_mul_f32 v92, v92, v117
    v_mul_f32 v93, v93, v117
    v_mul_f32 v94, v94, v117
    v_mul_f32 v95, v95, v117
    v_add_u32 v120, 0, v119
    v_lshrrev_b32 v121, 3, v120
    v_lshlrev_b32 v121, 10, v121
    v_and_b32 v122, 3, v120
    v_lshl_add_u32 v121, v122, 8, v121
    v_bfe_u32 v122, v120, 2, 1
    v_lshl_add_u32 v121, v122, 3, v121
    v_add_u32 v121, v121, v118
    v_cvt_pk_bf16_f32 v124, v84, v85
    v_cvt_pk_bf16_f32 v125, v86, v87
    buffer_store_dwordx2 v[124:125], v121, s[12:15], 0 offen sc1
    s_nop 1
    v_add_u32 v120, 2, v119
    v_lshrrev_b32 v121, 3, v120
    v_lshlrev_b32 v121, 10, v121
    v_and_b32 v122, 3, v120
    v_lshl_add_u32 v121, v122, 8, v121
    v_bfe_u32 v122, v120, 2, 1
    v_lshl_add_u32 v121, v122, 3, v121
    v_add_u32 v121, v121, v118
    v_cvt_pk_bf16_f32 v124, v88, v89
    v_cvt_pk_bf16_f32 v125, v90, v91
    buffer_store_dwordx2 v[124:125], v121, s[12:15], 0 offen sc1
    s_nop 1
    v_add_u32 v120, 4, v119
    v_lshrrev_b32 v121, 3, v120
    v_lshlrev_b32 v121, 10, v121
    v_and_b32 v122, 3, v120
    v_lshl_add_u32 v121, v122, 8, v121
    v_bfe_u32 v122, v120, 2, 1
    v_lshl_add_u32 v121, v122, 3, v121
    v_add_u32 v121, v121, v118
    v_cvt_pk_bf16_f32 v124, v92, v93
    v_cvt_pk_bf16_f32 v125, v94, v95
    v_cmp_gt_u32 vcc, 32, v1
    v_mov_b32 v122, 0x7ffffff0
    s_nop 0
    v_cndmask_b32 v121, v122, v121, vcc
    buffer_store_dwordx2 v[124:125], v121, s[12:15], 0 offen sc1
    s_nop 1
    s_waitcnt vmcnt(0)
    s_barrier
    s_cmp_lg_u32 s16, 0
    s_cbranch_scc1 L_k2_nosig
    s_add_u32 s48, s4, 0x1A00000
    s_addc_u32 s49, s5, 0
    s_mov_b32 s50, 8192
    s_mov_b32 s51, 0x00020000
    s_lshl_b32 s26, s18, 10
    v_mov_b32 v116, s26
    v_mov_b32 v117, 1
    v_cmp_eq_u32 vcc, 0, v1
    s_and_saveexec_b64 s[52:53], vcc
    buffer_atomic_add v117, v116, s[48:51], 0 offen sc1
    s_mov_b64 exec, s[52:53]
L_k2_nosig:
L_k2_end:
    s_endpgm
L_k2_mlp:
    s_barrier
    s_load_dwordx2 s[6:7], s[0:1], 16
    s_load_dwordx4 s[24:27], s[0:1], 48
    s_load_dwordx2 s[48:49], s[0:1], 0
    s_load_dwordx2 s[52:53], s[0:1], 64
    s_sub_u32 s40, s16, 8
    s_and_b32 s28, s2, 7
    s_lshr_b32 s29, s2, 3
    s_lshl_b32 s28, s28, 2
    s_and_b32 s30, s29, 3
    s_add_u32 s41, s28, s30
    s_lshr_b32 s42, s29, 2
    v_add_u32 v12, 0, v1
    v_mul_u32_u24 v13, 0xcccd, v12
    v_lshrrev_b32 v13, 19, v13
    v_mul_u32_u24 v14, 10, v13
    v_sub_u32 v12, v12, v14
    v_mul_u32_u24 v13, 1280, v13
    v_lshl_add_u32 v2, v12, 4, v13
    v_add_u32 v12, 64, v1
    v_mul_u32_u24 v13, 0xcccd, v12
    v_lshrrev_b32 v13, 19, v13
    v_mul_u32_u24 v14, 10, v13
    v_sub_u32 v12, v12, v14
    v_mul_u32_u24 v13, 1280, v13
    v_lshl_add_u32 v3, v12, 4, v13
    v_subrev_u32 v3, 1024, v3
    v_add_u32 v12, 128, v1
    v_mul_u32_u24 v13, 0xcccd, v12
    v_lshrrev_b32 v13, 19, v13
    v_mul_u32_u24 v14, 10, v13
    v_sub_u32 v12, v12, v14
    v_mul_u32_u24 v13, 1280, v13
    v_lshl_add_u32 v4, v12, 4, v13
    v_subrev_u32 v4, 2048, v4
    v_add_u32 v12, 192, v1
    v_mul_u32_u24 v13, 0xcccd, v12
    v_lshrrev_b32 v13, 19, v13
    v_mul_u32_u24 v14, 10, v13
    v_sub_u32 v12, v12, v14
    v_mul_u32_u24 v13, 1280, v13
    v_lshl_add_u32 v5, v12, 4, v13
    v_subrev_u32 v5, 3072, v5
    v_add_u32 v12, 256, v1
    v_mul_u32_u24 v13, 0xcccd, v12
    v_lshrrev_b32 v13, 19, v13
    v_mul_u32_u24 v14, 10, v13
    v_sub_u32 v12, v12, v14
    v_mul_u32_u24 v13, 1280, v13
    v_lshl_add_u32 v6, v12, 4, v13
    v_lshlrev_b32 v7, 4, v1
    v_lshrrev_b32 v12, 2, v1
    v_mul_u32_u24 v8, 160, v12
    v_and_b32 v12, 3, v1
    v_lshl_add_u32 v8, v12, 3, v8
    v_add_u32 v9, 114688, v8
    v_add_u32 v15, 49152, v8
    v_add_u32 v8, 73728, v8
    s_lshl_b32 s28, s41, 2
    s_add_u32 s28, s28, s40
    s_mul_i32 s44, s28, 69632
    s_add_u32 s50, s44, 20480
    s_mul_i32 s46, s42, 160
    s_lshl_b32 s28, s28, 4
    v_and_b32 v12, 15, v1
    v_add_u32 v12, s28, v12
    v_mul_u32_u24 v10, 1280, v12
    v_lshrrev_b32 v12, 4, v1
    v_lshl_add_u32 v11, v12, 3, s46
    v_add_u32 v10, v10, v11
    s_waitcnt lgkmcnt(0)
    s_mov_b32 s8, s24
    s_mov_b32 s9, s25
    s_mov_b32 s10, 1966080
    s_mov_b32 s11, 0x00020000
    s_add_u32 s12, s4, 9437184
    s_addc_u32 s13, s5, 0
    s_mov_b32 s14, 8912896
    s_mov_b32 s15, 0x00020000
    s_mov_b32 s20, s6
    s_mov_b32 s21, s7
    s_mov_b32 s22, 819200
    s_mov_b32 s23, 0x00020000
    s_mov_b32 s28, s48
    s_mov_b32 s29, s49
    s_mov_b32 s30, 2621440
    s_mov_b32 s31, 0x00020000
    s_mov_b32 s64, s52
    s_mov_b32 s65, s53
    s_mov_b32 s66, 2621440
    s_mov_b32 s67, 0x00020000
    s_mov_b32 s36, s26
    s_mov_b32 s37, s27
    s_mov_b32 s38, 1280
    s_mov_b32 s39, 0x00020000
    s_add_u32 s60, s4, 27262976
    s_addc_u32 s61, s5, 0
    s_mov_b32 s62, 8192
    s_mov_b32 s63, 0x00020000
    s_mul_i32 s57, s40, 5120
    s_mul_i32 s58, s40, 40960
    s_add_u32 s58, s58, s46
    s_add_u32 s47, s57, 73728
    s_mov_b32 m0, s47
    s_add_u32 s59, s58, 0
    s_add_u32 s47, s47, 4096
    buffer_load_dwordx4 v2, s[8:11], s59 offen offset:0 lds
    buffer_load_dwordx4 v3, s[8:11], s59 offen offset:1024 lds
    buffer_load_dwordx4 v4, s[8:11], s59 offen offset:2048 lds
    buffer_load_dwordx4 v5, s[8:11], s59 offen offset:3072 lds
    s_mov_b32 m0, s47
    s_nop 0
    buffer_load_dwordx4 v6, s[8:11], s59 offen lds
    s_cmp_ge_u32 s40, 3
    s_cbranch_scc1 L_k4_sk_2
    s_add_u32 s47, s57, 94208
    s_mov_b32 m0, s47
    s_add_u32 s59, s58, 163840
    s_add_u32 s47, s47, 4096
    buffer_load_dwordx4 v2, s[8:11], s59 offen offset:0 lds
    buffer_load_dwordx4 v3, s[8:11], s59 offen offset:1024 lds
    buffer_load_dwordx4 v4, s[8:11], s59 offen offset:2048 lds
    buffer_load_dwordx4 v5, s[8:11], s59 offen offset:3072 lds
    s_mov_b32 m0, s47
    s_nop 0
    buffer_load_dwordx4 v6, s[8:11], s59 offen lds
L_k4_sk_2:
    s_add_u32 s59, s50, 0
    buffer_load_dwordx4 v[68:71], v7, s[12:15], s59 offen
    s_add_u32 s59, s50, 1024
    buffer_load_dwordx4 v[72:75], v7, s[12:15], s59 offen
    s_add_u32 s59, s50, 2048
    buffer_load_dwordx4 v[76:79], v7, s[12:15], s59 offen
    s_add_u32 s59, s50, 3072
    buffer_load_dwordx4 v[80:83], v7, s[12:15], s59 offen
    s_add_u32 s59, s50, 4096
    buffer_load_dwordx4 v[84:87], v7, s[12:15], s59 offen
    s_add_u32 s59, s50, 5120
    buffer_load_dwordx4 v[88:91], v7, s[12:15], s59 offen
    s_add_u32 s59, s50, 6144
    buffer_load_dwordx4 v[92:95], v7, s[12:15], s59 offen
    s_add_u32 s47, s57, 109568
    s_mov_b32 m0, s47
    s_add_u32 s59, s58, 286720
    s_add_u32 s47, s47, 4096
    buffer_load_dwordx4 v2, s[8:11], s59 offen offset:0 lds
    buffer_load_dwordx4 v3, s[8:11], s59 offen offset:1024 lds
    buffer_load_dwordx4 v4, s[8:11], s59 offen offset:2048 lds
    buffer_load_dwordx4 v5, s[8:11], s59 offen offset:3072 lds
    s_mov_b32 m0, s47
    s_nop 0
    buffer_load_dwordx4 v6, s[8:11], s59 offen lds
    s_cmp_ge_u32 s40, 3
    s_cbranch_scc1 L_k4_sk_4
    s_add_u32 s47, s57, 130048
    s_mov_b32 m0, s47
    s_add_u32 s59, s58, 450560
    s_add_u32 s47, s47, 4096
    buffer_load_dwordx4 v2, s[8:11], s59 offen offset:0 lds
    buffer_load_dwordx4 v3, s[8:11], s59 offen offset:1024 lds
    buffer_load_dwordx4 v4, s[8:11], s59 offen offset:2048 lds
    buffer_load_dwordx4 v5, s[8:11], s59 offen offset:3072 lds
    s_mov_b32 m0, s47
    s_nop 0
    buffer_load_dwordx4 v6, s[8:11], s59 offen lds
L_k4_sk_4:
    s_add_u32 s59, s50, 7168
    buffer_load_dwordx4 v[96:99], v7, s[12:15], s59 offen
    s_add_u32 s59, s50, 8192
    buffer_load_dwordx4 v[100:103], v7, s[12:15], s59 offen
    s_add_u32 s59, s50, 9216
    buffer_load_dwordx4 v[104:107], v7, s[12:15], s59 offen
    s_add_u32 s59, s50, 10240
    buffer_load_dwordx4 v[108:111], v7, s[12:15], s59 offen
    s_add_u32 s59, s50, 11264
    buffer_load_dwordx4 v[112:115], v7, s[12:15], s59 offen
    s_add_u32 s59, s50, 12288
    buffer_load_dwordx4 v[116:119], v7, s[12:15], s59 offen
    s_add_u32 s59, s50, 13312
    buffer_load_dwordx4 v[120:123], v7, s[12:15], s59 offen
    v_mov_b32 v16, 0
    v_mov_b32 v17, 0
    v_mov_b32 v18, 0
    v_mov_b32 v19, 0
    v_mov_b32 v20, 0
    v_mov_b32 v21, 0
    v_mov_b32 v22, 0
    v_mov_b32 v23, 0
    v_mov_b32 v24, 0
    v_mov_b32 v25, 0
    v_mov_b32 v26, 0
    v_mov_b32 v27, 0
    v_mov_b32 v28, 0
    v_mov_b32 v29, 0
    v_mov_b32 v30, 0
    v_mov_b32 v31, 0
    v_mov_b32 v32, 0
    v_mov_b32 v33, 0
    v_mov_b32 v34, 0
    v_mov_b32 v35, 0
    s_waitcnt vmcnt(12)
    s_barrier
    ds_read_b64_tr_b16 v[36:37], v8 offset:0
    ds_read_b64_tr_b16 v[38:39], v8 offset:2560
    ds_read_b64_tr_b16 v[40:41], v8 offset:32
    ds_read_b64_tr_b16 v[42:43], v8 offset:2592
    ds_read_b64_tr_b16 v[44:45], v8 offset:64
    ds_read_b64_tr_b16 v[46:47], v8 offset:2624
    ds_read_b64_tr_b16 v[48:49], v8 offset:96
    ds_read_b64_tr_b16 v[50:51], v8 offset:2656
    ds_read_b64_tr_b16 v[52:53], v8 offset:128
    ds_read_b64_tr_b16 v[54:55], v8 offset:2688
    ds_read_b64_tr_b16 v[56:57], v8 offset:5120
    ds_read_b64_tr_b16 v[58:59], v8 offset:7680
    s_waitcnt lgkmcnt(10)
    ds_read_b64_tr_b16 v[60:61], v8 offset:5152
    ds_read_b64_tr_b16 v[62:63], v8 offset:7712
    v_mfma_f32_16x16x32_bf16 v[16:19], v[36:39], v[68:71], v[16:19]
    s_waitcnt lgkmcnt(10)
    ds_read_b64_tr_b16 v[64:65], v8 offset:5184
    ds_read_b64_tr_b16 v[66:67], v8 offset:7744
    v_mfma_f32_16x16x32_bf16 v[20:23], v[40:43], v[68:71], v[20:23]
    s_waitcnt lgkmcnt(10)
    ds_read_b64_tr_b16 v[36:37], v8 offset:5216
    ds_read_b64_tr_b16 v[38:39], v8 offset:7776
    v_mfma_f32_16x16x32_bf16 v[24:27], v[44:47], v[68:71], v[24:27]
    s_waitcnt lgkmcnt(10)
    ds_read_b64_tr_b16 v[40:41], v8 offset:5248
    ds_read_b64_tr_b16 v[42:43], v8 offset:7808
    v_mfma_f32_16x16x32_bf16 v[28:31], v[48:51], v[68:71], v[28:31]
    s_waitcnt lgkmcnt(10)
    ds_read_b64_tr_b16 v[44:45], v8 offset:10240
    ds_read_b64_tr_b16 v[46:47], v8 offset:12800
    v_mfma_f32_16x16x32_bf16 v[32:35], v[52:55], v[68:71], v[32:35]
    s_waitcnt lgkmcnt(10)
    ds_read_b64_tr_b16 v[48:49], v8 offset:10272
    ds_read_b64_tr_b16 v[50:51], v8 offset:12832
    v_mfma_f32_16x16x32_bf16 v[16:19], v[56:59], v[72:75], v[16:19]
    s_waitcnt lgkmcnt(10)
    ds_read_b64_tr_b16 v[52:53], v8 offset:10304
    ds_read_b64_tr_b16 v[54:55], v8 offset:12864
    v_mfma_f32_16x16x32_bf16 v[20:23], v[60:63], v[72:75], v[20:23]
    s_waitcnt lgkmcnt(10)
    ds_read_b64_tr_b16 v[56:57], v8 offset:10336
    ds_read_b64_tr_b16 v[58:59], v8 offset:12896
    v_mfma_f32_16x16x32_bf16 v[24:27], v[64:67], v[72:75], v[24:27]
    s_waitcnt lgkmcnt(10)
    ds_read_b64_tr_b16 v[60:61], v8 offset:10368
    ds_read_b64_tr_b16 v[62:63], v8 offset:12928
    v_mfma_f32_16x16x32_bf16 v[28:31], v[36:39], v[72:75], v[28:31]
    s_waitcnt lgkmcnt(10)
    ds_read_b64_tr_b16 v[64:65], v8 offset:15360
    ds_read_b64_tr_b16 v[66:67], v8 offset:17920
    v_mfma_f32_16x16x32_bf16 v[32:35], v[40:43], v[72:75], v[32:35]
    s_waitcnt lgkmcnt(10)
    ds_read_b64_tr_b16 v[36:37], v8 offset:15392
    ds_read_b64_tr_b16 v[38:39], v8 offset:17952
    v_mfma_f32_16x16x32_bf16 v[16:19], v[44:47], v[76:79], v[16:19]
    s_waitcnt lgkmcnt(10)
    ds_read_b64_tr_b16 v[40:41], v8 offset:15424
    ds_read_b64_tr_b16 v[42:43], v8 offset:17984
    v_mfma_f32_16x16x32_bf16 v[20:23], v[48:51], v[76:79], v[20:23]
    s_waitcnt lgkmcnt(10)
    ds_read_b64_tr_b16 v[44:45], v8 offset:15456
    ds_read_b64_tr_b16 v[46:47], v8 offset:18016
    v_mfma_f32_16x16x32_bf16 v[24:27], v[52:55], v[76:79], v[24:27]
    s_waitcnt lgkmcnt(10)
    ds_read_b64_tr_b16 v[48:49], v8 offset:15488
    ds_read_b64_tr_b16 v[50:51], v8 offset:18048
    v_mfma_f32_16x16x32_bf16 v[28:31], v[56:59], v[76:79], v[28:31]
    s_waitcnt lgkmcnt(10)
    ds_read_b64_tr_b16 v[52:53], v8 offset:20480
    ds_read_b64_tr_b16 v[54:55], v8 offset:23040
    v_mfma_f32_16x16x32_bf16 v[32:35], v[60:63], v[76:79], v[32:35]
    s_waitcnt lgkmcnt(10)
    ds_read_b64_tr_b16 v[56:57], v8 offset:20512
    ds_read_b64_tr_b16 v[58:59], v8 offset:23072
    v_mfma_f32_16x16x32_bf16 v[16:19], v[64:67], v[80:83], v[16:19]
    s_waitcnt lgkmcnt(10)
    ds_read_b64_tr_b16 v[60:61], v8 offset:20544
    ds_read_b64_tr_b16 v[62:63], v8 offset:23104
    v_mfma_f32_16x16x32_bf16 v[20:23], v[36:39], v[80:83], v[20:23]
    s_waitcnt lgkmcnt(10)
    ds_read_b64_tr_b16 v[64:65], v8 offset:20576
    ds_read_b64_tr_b16 v[66:67], v8 offset:23136
    v_mfma_f32_16x16x32_bf16 v[24:27], v[40:43], v[80:83], v[24:27]
    s_waitcnt lgkmcnt(10)
    ds_read_b64_tr_b16 v[36:37], v8 offset:20608
    ds_read_b64_tr_b16 v[38:39], v8 offset:23168
    v_mfma_f32_16x16x32_bf16 v[28:31], v[44:47], v[80:83], v[28:31]
    s_waitcnt lgkmcnt(10)
    ds_read_b64_tr_b16 v[40:41], v8 offset:25600
    ds_read_b64_tr_b16 v[42:43], v8 offset:28160
    v_mfma_f32_16x16x32_bf16 v[32:35], v[48:51], v[80:83], v[32:35]
    s_waitcnt lgkmcnt(10)
    ds_read_b64_tr_b16 v[44:45], v8 offset:25632
    ds_read_b64_tr_b16 v[46:47], v8 offset:28192
    v_mfma_f32_16x16x32_bf16 v[16:19], v[52:55], v[84:87], v[16:19]
    s_waitcnt lgkmcnt(10)
    ds_read_b64_tr_b16 v[48:49], v8 offset:25664
    ds_read_b64_tr_b16 v[50:51], v8 offset:28224
    v_mfma_f32_16x16x32_bf16 v[20:23], v[56:59], v[84:87], v[20:23]
    s_waitcnt lgkmcnt(10)
    ds_read_b64_tr_b16 v[52:53], v8 offset:25696
    ds_read_b64_tr_b16 v[54:55], v8 offset:28256
    v_mfma_f32_16x16x32_bf16 v[24:27], v[60:63], v[84:87], v[24:27]
    s_waitcnt lgkmcnt(10)
    ds_read_b64_tr_b16 v[56:57], v8 offset:25728
    ds_read_b64_tr_b16 v[58:59], v8 offset:28288
    v_mfma_f32_16x16x32_bf16 v[28:31], v[64:67], v[84:87], v[28:31]
    s_waitcnt lgkmcnt(10)
    ds_read_b64_tr_b16 v[60:61], v8 offset:30720
    ds_read_b64_tr_b16 v[62:63], v8 offset:33280
    v_mfma_f32_16x16x32_bf16 v[32:35], v[36:39], v[84:87], v[32:35]
    s_waitcnt lgkmcnt(10)
    ds_read_b64_tr_b16 v[64:65], v8 offset:30752
    ds_read_b64_tr_b16 v[66:67], v8 offset:33312
    v_mfma_f32_16x16x32_bf16 v[16:19], v[40:43], v[88:91], v[16:19]
    s_waitcnt lgkmcnt(10)
    ds_read_b64_tr_b16 v[36:37], v8 offset:30784
    ds_read_b64_tr_b16 v[38:39], v8 offset:33344
    v_mfma_f32_16x16x32_bf16 v[20:23], v[44:47], v[88:91], v[20:23]
    s_waitcnt lgkmcnt(10)
    ds_read_b64_tr_b16 v[40:41], v8 offset:30816
    ds_read_b64_tr_b16 v[42:43], v8 offset:33376
    v_mfma_f32_16x16x32_bf16 v[24:27], v[48:51], v[88:91], v[24:27]
    s_waitcnt lgkmcnt(10)
    ds_read_b64_tr_b16 v[44:45], v8 offset:30848
    ds_read_b64_tr_b16 v[46:47], v8 offset:33408
    v_mfma_f32_16x16x32_bf16 v[28:31], v[52:55], v[88:91], v[28:31]
    s_waitcnt lgkmcnt(10)
    v_mfma_f32_16x16x32_bf16 v[32:35], v[56:59], v[88:91], v[32:35]
    s_waitcnt lgkmcnt(8)
    v_mfma_f32_16x16x32_bf16 v[16:19], v[60:63], v[92:95], v[16:19]
    s_waitcnt lgkmcnt(6)
    v_mfma_f32_16x16x32_bf16 v[20:23], v[64:67], v[92:95], v[20:23]
    s_waitcnt lgkmcnt(4)
    v_mfma_f32_16x16x32_bf16 v[24:27], v[36:39], v[92:95], v[24:27]
    s_waitcnt lgkmcnt(2)
    v_mfma_f32_16x16x32_bf16 v[28:31], v[40:43], v[92:95], v[28:31]
    s_waitcnt lgkmcnt(0)
    v_mfma_f32_16x16x32_bf16 v[32:35], v[44:47], v[92:95], v[32:35]
    s_waitcnt vmcnt(0)
    s_barrier
    s_add_u32 s47, s57, 73728
    s_mov_b32 m0, s47
    s_add_u32 s59, s58, 573440
    s_add_u32 s47, s47, 4096
    buffer_load_dwordx4 v2, s[8:11], s59 offen offset:0 lds
    buffer_load_dwordx4 v3, s[8:11], s59 offen offset:1024 lds
    buffer_load_dwordx4 v4, s[8:11], s59 offen offset:2048 lds
    buffer_load_dwordx4 v5, s[8:11], s59 offen offset:3072 lds
    s_mov_b32 m0, s47
    s_nop 0
    buffer_load_dwordx4 v6, s[8:11], s59 offen lds
    s_cmp_ge_u32 s40, 3
    s_cbranch_scc1 L_k4_sk_6
    s_add_u32 s47, s57, 94208
    s_mov_b32 m0, s47
    s_add_u32 s59, s58, 737280
    s_add_u32 s47, s47, 4096
    buffer_load_dwordx4 v2, s[8:11], s59 offen offset:0 lds
    buffer_load_dwordx4 v3, s[8:11], s59 offen offset:1024 lds
    buffer_load_dwordx4 v4, s[8:11], s59 offen offset:2048 lds
    buffer_load_dwordx4 v5, s[8:11], s59 offen offset:3072 lds
    s_mov_b32 m0, s47
    s_nop 0
    buffer_load_dwordx4 v6, s[8:11], s59 offen lds
L_k4_sk_6:
    s_add_u32 s59, s50, 14336
    buffer_load_dwordx4 v[68:71], v7, s[12:15], s59 offen
    s_add_u32 s59, s50, 15360
    buffer_load_dwordx4 v[72:75], v7, s[12:15], s59 offen
    s_add_u32 s59, s50, 16384
    buffer_load_dwordx4 v[76:79], v7, s[12:15], s59 offen
    s_add_u32 s59, s50, 17408
    buffer_load_dwordx4 v[80:83], v7, s[12:15], s59 offen
    s_add_u32 s59, s50, 18432
    buffer_load_dwordx4 v[84:87], v7, s[12:15], s59 offen
    s_add_u32 s59, s50, 19456
    buffer_load_dwordx4 v[88:91], v7, s[12:15], s59 offen
    s_add_u32 s59, s50, 20480
    buffer_load_dwordx4 v[92:95], v7, s[12:15], s59 offen
    ds_read_b64_tr_b16 v[36:37], v8 offset:35840
    ds_read_b64_tr_b16 v[38:39], v8 offset:38400
    ds_read_b64_tr_b16 v[40:41], v8 offset:35872
    ds_read_b64_tr_b16 v[42:43], v8 offset:38432
    ds_read_b64_tr_b16 v[44:45], v8 offset:35904
    ds_read_b64_tr_b16 v[46:47], v8 offset:38464
    ds_read_b64_tr_b16 v[48:49], v8 offset:35936
    ds_read_b64_tr_b16 v[50:51], v8 offset:38496
    ds_read_b64_tr_b16 v[52:53], v8 offset:35968
    ds_read_b64_tr_b16 v[54:55], v8 offset:38528
    ds_read_b64_tr_b16 v[56:57], v9 offset:0
    ds_read_b64_tr_b16 v[58:59], v9 offset:2560
    s_waitcnt lgkmcnt(10)
    ds_read_b64_tr_b16 v[60:61], v9 offset:32
    ds_read_b64_tr_b16 v[62:63], v9 offset:2592
    v_mfma_f32_16x16x32_bf16 v[16:19], v[36:39], v[96:99], v[16:19]
    s_waitcnt lgkmcnt(10)
    ds_read_b64_tr_b16 v[64:65], v9 offset:64
    ds_read_b64_tr_b16 v[66:67], v9 offset:2624
    v_mfma_f32_16x16x32_bf16 v[20:23], v[40:43], v[96:99], v[20:23]
    s_waitcnt lgkmcnt(10)
    ds_read_b64_tr_b16 v[36:37], v9 offset:96
    ds_read_b64_tr_b16 v[38:39], v9 offset:2656
    v_mfma_f32_16x16x32_bf16 v[24:27], v[44:47], v[96:99], v[24:27]
    s_waitcnt lgkmcnt(10)
    ds_read_b64_tr_b16 v[40:41], v9 offset:128
    ds_read_b64_tr_b16 v[42:43], v9 offset:2688
    v_mfma_f32_16x16x32_bf16 v[28:31], v[48:51], v[96:99], v[28:31]
    s_waitcnt lgkmcnt(10)
    ds_read_b64_tr_b16 v[44:45], v9 offset:5120
    ds_read_b64_tr_b16 v[46:47], v9 offset:7680
    v_mfma_f32_16x16x32_bf16 v[32:35], v[52:55], v[96:99], v[32:35]
    s_waitcnt lgkmcnt(10)
    ds_read_b64_tr_b16 v[48:49], v9 offset:5152
    ds_read_b64_tr_b16 v[50:51], v9 offset:7712
    v_mfma_f32_16x16x32_bf16 v[16:19], v[56:59], v[100:103], v[16:19]
    s_waitcnt lgkmcnt(10)
    ds_read_b64_tr_b16 v[52:53], v9 offset:5184
    ds_read_b64_tr_b16 v[54:55], v9 offset:7744
    v_mfma_f32_16x16x32_bf16 v[20:23], v[60:63], v[100:103], v[20:23]
    s_waitcnt lgkmcnt(10)
    ds_read_b64_tr_b16 v[56:57], v9 offset:5216
    ds_read_b64_tr_b16 v[58:59], v9 offset:7776
    v_mfma_f32_16x16x32_bf16 v[24:27], v[64:67], v[100:103], v[24:27]
    s_waitcnt lgkmcnt(10)
    ds_read_b64_tr_b16 v[60:61], v9 offset:5248
    ds_read_b64_tr_b16 v[62:63], v9 offset:7808
    v_mfma_f32_16x16x32_bf16 v[28:31], v[36:39], v[100:103], v[28:31]
    s_waitcnt lgkmcnt(10)
    ds_read_b64_tr_b16 v[64:65], v9 offset:10240
    ds_read_b64_tr_b16 v[66:67], v9 offset:12800
    v_mfma_f32_16x16x32_bf16 v[32:35], v[40:43], v[100:103], v[32:35]
    s_waitcnt lgkmcnt(10)
    ds_read_b64_tr_b16 v[36:37], v9 offset:10272
    ds_read_b64_tr_b16 v[38:39], v9 offset:12832
    v_mfma_f32_16x16x32_bf16 v[16:19], v[44:47], v[104:107], v[16:19]
    s_waitcnt lgkmcnt(10)
    ds_read_b64_tr_b16 v[40:41], v9 offset:10304
    ds_read_b64_tr_b16 v[42:43], v9 offset:12864
    v_mfma_f32_16x16x32_bf16 v[20:23], v[48:51], v[104:107], v[20:23]
    s_waitcnt lgkmcnt(10)
    ds_read_b64_tr_b16 v[44:45], v9 offset:10336
    ds_read_b64_tr_b16 v[46:47], v9 offset:12896
    v_mfma_f32_16x16x32_bf16 v[24:27], v[52:55], v[104:107], v[24:27]
    s_waitcnt lgkmcnt(10)
    ds_read_b64_tr_b16 v[48:49], v9 offset:10368
    ds_read_b64_tr_b16 v[50:51], v9 offset:12928
    v_mfma_f32_16x16x32_bf16 v[28:31], v[56:59], v[104:107], v[28:31]
    s_waitcnt lgkmcnt(10)
    ds_read_b64_tr_b16 v[52:53], v9 offset:15360
    ds_read_b64_tr_b16 v[54:55], v9 offset:17920
    v_mfma_f32_16x16x32_bf16 v[32:35], v[60:63], v[104:107], v[32:35]
    s_waitcnt lgkmcnt(10)
    ds_read_b64_tr_b16 v[56:57], v9 offset:15392
    ds_read_b64_tr_b16 v[58:59], v9 offset:17952
    v_mfma_f32_16x16x32_bf16 v[16:19], v[64:67], v[108:111], v[16:19]
    s_waitcnt lgkmcnt(10)
    ds_read_b64_tr_b16 v[60:61], v9 offset:15424
    ds_read_b64_tr_b16 v[62:63], v9 offset:17984
    v_mfma_f32_16x16x32_bf16 v[20:23], v[36:39], v[108:111], v[20:23]
    s_waitcnt lgkmcnt(10)
    ds_read_b64_tr_b16 v[64:65], v9 offset:15456
    ds_read_b64_tr_b16 v[66:67], v9 offset:18016
    v_mfma_f32_16x16x32_bf16 v[24:27], v[40:43], v[108:111], v[24:27]
    s_waitcnt lgkmcnt(10)
    ds_read_b64_tr_b16 v[36:37], v9 offset:15488
    ds_read_b64_tr_b16 v[38:39], v9 offset:18048
    v_mfma_f32_16x16x32_bf16 v[28:31], v[44:47], v[108:111], v[28:31]
    s_waitcnt lgkmcnt(10)
    ds_read_b64_tr_b16 v[40:41], v9 offset:20480
    ds_read_b64_tr_b16 v[42:43], v9 offset:23040
    v_mfma_f32_16x16x32_bf16 v[32:35], v[48:51], v[108:111], v[32:35]
    s_waitcnt lgkmcnt(10)
    ds_read_b64_tr_b16 v[44:45], v9 offset:20512
    ds_read_b64_tr_b16 v[46:47], v9 offset:23072
    v_mfma_f32_16x16x32_bf16 v[16:19], v[52:55], v[112:115], v[16:19]
    s_waitcnt lgkmcnt(10)
    ds_read_b64_tr_b16 v[48:49], v9 offset:20544
    ds_read_b64_tr_b16 v[50:51], v9 offset:23104
    v_mfma_f32_16x16x32_bf16 v[20:23], v[56:59], v[112:115], v[20:23]
    s_waitcnt lgkmcnt(10)
    ds_read_b64_tr_b16 v[52:53], v9 offset:20576
    ds_read_b64_tr_b16 v[54:55], v9 offset:23136
    v_mfma_f32_16x16x32_bf16 v[24:27], v[60:63], v[112:115], v[24:27]
    s_waitcnt lgkmcnt(10)
    ds_read_b64_tr_b16 v[56:57], v9 offset:20608
    ds_read_b64_tr_b16 v[58:59], v9 offset:23168
    v_mfma_f32_16x16x32_bf16 v[28:31], v[64:67], v[112:115], v[28:31]
    s_waitcnt lgkmcnt(10)
    ds_read_b64_tr_b16 v[60:61], v9 offset:25600
    ds_read_b64_tr_b16 v[62:63], v9 offset:28160
    v_mfma_f32_16x16x32_bf16 v[32:35], v[36:39], v[112:115], v[32:35]
    s_waitcnt lgkmcnt(10)
    ds_read_b64_tr_b16 v[64:65], v9 offset:25632
    ds_read_b64_tr_b16 v[66:67], v9 offset:28192
    v_mfma_f32_16x16x32_bf16 v[16:19], v[40:43], v[116:119], v[16:19]
    s_waitcnt lgkmcnt(10)
    ds_read_b64_tr_b16 v[36:37], v9 offset:25664
    ds_read_b64_tr_b16 v[38:39], v9 offset:28224
    v_mfma_f32_16x16x32_bf16 v[20:23], v[44:47], v[116:119], v[20:23]
    s_waitcnt lgkmcnt(10)
    ds_read_b64_tr_b16 v[40:41], v9 offset:25696
    ds_read_b64_tr_b16 v[42:43], v9 offset:28256
    v_mfma_f32_16x16x32_bf16 v[24:27], v[48:51], v[116:119], v[24:27]
    s_waitcnt lgkmcnt(10)
    ds_read_b64_tr_b16 v[44:45], v9 offset:25728
    ds_read_b64_tr_b16 v[46:47], v9 offset:28288
    v_mfma_f32_16x16x32_bf16 v[28:31], v[52:55], v[116:119], v[28:31]
    s_waitcnt lgkmcnt(10)
    v_mfma_f32_16x16x32_bf16 v[32:35], v[56:59], v[116:119], v[32:35]
    s_waitcnt lgkmcnt(8)
    v_mfma_f32_16x16x32_bf16 v[16:19], v[60:63], v[120:123], v[16:19]
    s_waitcnt lgkmcnt(6)
    v_mfma_f32_16x16x32_bf16 v[20:23], v[64:67], v[120:123], v[20:23]
    s_waitcnt lgkmcnt(4)
    v_mfma_f32_16x16x32_bf16 v[24:27], v[36:39], v[120:123], v[24:27]
    s_waitcnt lgkmcnt(2)
    v_mfma_f32_16x16x32_bf16 v[28:31], v[40:43], v[120:123], v[28:31]
    s_waitcnt lgkmcnt(0)
    v_mfma_f32_16x16x32_bf16 v[32:35], v[44:47], v[120:123], v[32:35]
    s_waitcnt vmcnt(0)
    s_barrier
    s_add_u32 s47, s57, 109568
    s_mov_b32 m0, s47
    s_add_u32 s59, s58, 860160
    s_add_u32 s47, s47, 4096
    buffer_load_dwordx4 v2, s[8:11], s59 offen offset:0 lds
    buffer_load_dwordx4 v3, s[8:11], s59 offen offset:1024 lds
    buffer_load_dwordx4 v4, s[8:11], s59 offen offset:2048 lds
    buffer_load_dwordx4 v5, s[8:11], s59 offen offset:3072 lds
    s_mov_b32 m0, s47
    s_nop 0
    buffer_load_dwordx4 v6, s[8:11], s59 offen lds
    s_cmp_ge_u32 s40, 3
    s_cbranch_scc1 L_k4_sk_8
    s_add_u32 s47, s57, 130048
    s_mov_b32 m0, s47
    s_add_u32 s59, s58, 1024000
    s_add_u32 s47, s47, 4096
    buffer_load_dwordx4 v2, s[8:11], s59 offen offset:0 lds
    buffer_load_dwordx4 v3, s[8:11], s59 offen offset:1024 lds
    buffer_load_dwordx4 v4, s[8:11], s59 offen offset:2048 lds
    buffer_load_dwordx4 v5, s[8:11], s59 offen offset:3072 lds
    s_mov_b32 m0, s47
    s_nop 0
    buffer_load_dwordx4 v6, s[8:11], s59 offen lds
L_k4_sk_8:
    s_add_u32 s59, s50, 21504
    buffer_load_dwordx4 v[96:99], v7, s[12:15], s59 offen
    s_add_u32 s59, s50, 22528
    buffer_load_dwordx4 v[100:103], v7, s[12:15], s59 offen
    s_add_u32 s59, s50, 23552
    buffer_load_dwordx4 v[104:107], v7, s[12:15], s59 offen
    s_add_u32 s59, s50, 24576
    buffer_load_dwordx4 v[108:111], v7, s[12:15], s59 offen
    s_add_u32 s59, s50, 25600
    buffer_load_dwordx4 v[112:115], v7, s[12:15], s59 offen
    s_add_u32 s59, s50, 26624
    buffer_load_dwordx4 v[116:119], v7, s[12:15], s59 offen
    s_add_u32 s59, s50, 27648
    buffer_load_dwordx4 v[120:123], v7, s[12:15], s59 offen
    ds_read_b64_tr_b16 v[36:37], v8 offset:0
    ds_read_b64_tr_b16 v[38:39], v8 offset:2560
    ds_read_b64_tr_b16 v[40:41], v8 offset:32
    ds_read_b64_tr_b16 v[42:43], v8 offset:2592
    ds_read_b64_tr_b16 v[44:45], v8 offset:64
    ds_read_b64_tr_b16 v[46:47], v8 offset:2624
    ds_read_b64_tr_b16 v[48:49], v8 offset:96
    ds_read_b64_tr_b16 v[50:51], v8 offset:2656
    ds_read_b64_tr_b16 v[52:53], v8 offset:128
    ds_read_b64_tr_b16 v[54:55], v8 offset:2688
    ds_read_b64_tr_b16 v[56:57], v8 offset:5120
    ds_read_b64_tr_b16 v[58:59], v8 offset:7680
    s_waitcnt lgkmcnt(10)
    ds_read_b64_tr_b16 v[60:61], v8 offset:5152
    ds_read_b64_tr_b16 v[62:63], v8 offset:7712
    v_mfma_f32_16x16x32_bf16 v[16:19], v[36:39], v[68:71], v[16:19]
    s_waitcnt lgkmcnt(10)
    ds_read_b64_tr_b16 v[64:65], v8 offset:5184
    ds_read_b64_tr_b16 v[66:67], v8 offset:7744
    v_mfma_f32_16x16x32_bf16 v[20:23], v[40:43], v[68:71], v[20:23]
    s_waitcnt lgkmcnt(10)
    ds_read_b64_tr_b16 v[36:37], v8 offset:5216
    ds_read_b64_tr_b16 v[38:39], v8 offset:7776
    v_mfma_f32_16x16x32_bf16 v[24:27], v[44:47], v[68:71], v[24:27]
    s_waitcnt lgkmcnt(10)
    ds_read_b64_tr_b16 v[40:41], v8 offset:5248
    ds_read_b64_tr_b16 v[42:43], v8 offset:7808
    v_mfma_f32_16x16x32_bf16 v[28:31], v[48:51], v[68:71], v[28:31]
    s_waitcnt lgkmcnt(10)
    ds_read_b64_tr_b16 v[44:45], v8 offset:10240
    ds_read_b64_tr_b16 v[46:47], v8 offset:12800
    v_mfma_f32_16x16x32_bf16 v[32:35], v[52:55], v[68:71], v[32:35]
    s_waitcnt lgkmcnt(10)
    ds_read_b64_tr_b16 v[48:49], v8 offset:10272
    ds_read_b64_tr_b16 v[50:51], v8 offset:12832
    v_mfma_f32_16x16x32_bf16 v[16:19], v[56:59], v[72:75], v[16:19]
    s_waitcnt lgkmcnt(10)
    ds_read_b64_tr_b16 v[52:53], v8 offset:10304
    ds_read_b64_tr_b16 v[54:55], v8 offset:12864
    v_mfma_f32_16x16x32_bf16 v[20:23], v[60:63], v[72:75], v[20:23]
    s_waitcnt lgkmcnt(10)
    ds_read_b64_tr_b16 v[56:57], v8 offset:10336
    ds_read_b64_tr_b16 v[58:59], v8 offset:12896
    v_mfma_f32_16x16x32_bf16 v[24:27], v[64:67], v[72:75], v[24:27]
    s_waitcnt lgkmcnt(10)
    ds_read_b64_tr_b16 v[60:61], v8 offset:10368
    ds_read_b64_tr_b16 v[62:63], v8 offset:12928
    v_mfma_f32_16x16x32_bf16 v[28:31], v[36:39], v[72:75], v[28:31]
    s_waitcnt lgkmcnt(10)
    ds_read_b64_tr_b16 v[64:65], v8 offset:15360
    ds_read_b64_tr_b16 v[66:67], v8 offset:17920
    v_mfma_f32_16x16x32_bf16 v[32:35], v[40:43], v[72:75], v[32:35]
    s_waitcnt lgkmcnt(10)
    ds_read_b64_tr_b16 v[36:37], v8 offset:15392
    ds_read_b64_tr_b16 v[38:39], v8 offset:17952
    v_mfma_f32_16x16x32_bf16 v[16:19], v[44:47], v[76:79], v[16:19]
    s_waitcnt lgkmcnt(10)
    ds_read_b64_tr_b16 v[40:41], v8 offset:15424
    ds_read_b64_tr_b16 v[42:43], v8 offset:17984
    v_mfma_f32_16x16x32_bf16 v[20:23], v[48:51], v[76:79], v[20:23]
    s_waitcnt lgkmcnt(10)
    ds_read_b64_tr_b16 v[44:45], v8 offset:15456
    ds_read_b64_tr_b16 v[46:47], v8 offset:18016
    v_mfma_f32_16x16x32_bf16 v[24:27], v[52:55], v[76:79], v[24:27]
    s_waitcnt lgkmcnt(10)
    ds_read_b64_tr_b16 v[48:49], v8 offset:15488
    ds_read_b64_tr_b16 v[50:51], v8 offset:18048
    v_mfma_f32_16x16x32_bf16 v[28:31], v[56:59], v[76:79], v[28:31]
    s_waitcnt lgkmcnt(10)
    ds_read_b64_tr_b16 v[52:53], v8 offset:20480
    ds_read_b64_tr_b16 v[54:55], v8 offset:23040
    v_mfma_f32_16x16x32_bf16 v[32:35], v[60:63], v[76:79], v[32:35]
    s_waitcnt lgkmcnt(10)
    ds_read_b64_tr_b16 v[56:57], v8 offset:20512
    ds_read_b64_tr_b16 v[58:59], v8 offset:23072
    v_mfma_f32_16x16x32_bf16 v[16:19], v[64:67], v[80:83], v[16:19]
    s_waitcnt lgkmcnt(10)
    ds_read_b64_tr_b16 v[60:61], v8 offset:20544
    ds_read_b64_tr_b16 v[62:63], v8 offset:23104
    v_mfma_f32_16x16x32_bf16 v[20:23], v[36:39], v[80:83], v[20:23]
    s_waitcnt lgkmcnt(10)
    ds_read_b64_tr_b16 v[64:65], v8 offset:20576
    ds_read_b64_tr_b16 v[66:67], v8 offset:23136
    v_mfma_f32_16x16x32_bf16 v[24:27], v[40:43], v[80:83], v[24:27]
    s_waitcnt lgkmcnt(10)
    ds_read_b64_tr_b16 v[36:37], v8 offset:20608
    ds_read_b64_tr_b16 v[38:39], v8 offset:23168
    v_mfma_f32_16x16x32_bf16 v[28:31], v[44:47], v[80:83], v[28:31]
    s_waitcnt lgkmcnt(10)
    ds_read_b64_tr_b16 v[40:41], v8 offset:25600
    ds_read_b64_tr_b16 v[42:43], v8 offset:28160
    v_mfma_f32_16x16x32_bf16 v[32:35], v[48:51], v[80:83], v[32:35]
    s_waitcnt lgkmcnt(10)
    ds_read_b64_tr_b16 v[44:45], v8 offset:25632
    ds_read_b64_tr_b16 v[46:47], v8 offset:28192
    v_mfma_f32_16x16x32_bf16 v[16:19], v[52:55], v[84:87], v[16:19]
    s_waitcnt lgkmcnt(10)
    ds_read_b64_tr_b16 v[48:49], v8 offset:25664
    ds_read_b64_tr_b16 v[50:51], v8 offset:28224
    v_mfma_f32_16x16x32_bf16 v[20:23], v[56:59], v[84:87], v[20:23]
    s_waitcnt lgkmcnt(10)
    ds_read_b64_tr_b16 v[52:53], v8 offset:25696
    ds_read_b64_tr_b16 v[54:55], v8 offset:28256
    v_mfma_f32_16x16x32_bf16 v[24:27], v[60:63], v[84:87], v[24:27]
    s_waitcnt lgkmcnt(10)
    ds_read_b64_tr_b16 v[56:57], v8 offset:25728
    ds_read_b64_tr_b16 v[58:59], v8 offset:28288
    v_mfma_f32_16x16x32_bf16 v[28:31], v[64:67], v[84:87], v[28:31]
    s_waitcnt lgkmcnt(10)
    ds_read_b64_tr_b16 v[60:61], v8 offset:30720
    ds_read_b64_tr_b16 v[62:63], v8 offset:33280
    v_mfma_f32_16x16x32_bf16 v[32:35], v[36:39], v[84:87], v[32:35]
    s_waitcnt lgkmcnt(10)
    ds_read_b64_tr_b16 v[64:65], v8 offset:30752
    ds_read_b64_tr_b16 v[66:67], v8 offset:33312
    v_mfma_f32_16x16x32_bf16 v[16:19], v[40:43], v[88:91], v[16:19]
    s_waitcnt lgkmcnt(10)
    ds_read_b64_tr_b16 v[36:37], v8 offset:30784
    ds_read_b64_tr_b16 v[38:39], v8 offset:33344
    v_mfma_f32_16x16x32_bf16 v[20:23], v[44:47], v[88:91], v[20:23]
    s_waitcnt lgkmcnt(10)
    ds_read_b64_tr_b16 v[40:41], v8 offset:30816
    ds_read_b64_tr_b16 v[42:43], v8 offset:33376
    v_mfma_f32_16x16x32_bf16 v[24:27], v[48:51], v[88:91], v[24:27]
    s_waitcnt lgkmcnt(10)
    ds_read_b64_tr_b16 v[44:45], v8 offset:30848
    ds_read_b64_tr_b16 v[46:47], v8 offset:33408
    v_mfma_f32_16x16x32_bf16 v[28:31], v[52:55], v[88:91], v[28:31]
    s_waitcnt lgkmcnt(10)
    v_mfma_f32_16x16x32_bf16 v[32:35], v[56:59], v[88:91], v[32:35]
    s_waitcnt lgkmcnt(8)
    v_mfma_f32_16x16x32_bf16 v[16:19], v[60:63], v[92:95], v[16:19]
    s_waitcnt lgkmcnt(6)
    v_mfma_f32_16x16x32_bf16 v[20:23], v[64:67], v[92:95], v[20:23]
    s_waitcnt lgkmcnt(4)
    v_mfma_f32_16x16x32_bf16 v[24:27], v[36:39], v[92:95], v[24:27]
    s_waitcnt lgkmcnt(2)
    v_mfma_f32_16x16x32_bf16 v[28:31], v[40:43], v[92:95], v[28:31]
    s_waitcnt lgkmcnt(0)
    v_mfma_f32_16x16x32_bf16 v[32:35], v[44:47], v[92:95], v[32:35]
    s_waitcnt vmcnt(0)
    s_barrier
    s_add_u32 s47, s57, 73728
    s_mov_b32 m0, s47
    s_add_u32 s59, s58, 1146880
    s_add_u32 s47, s47, 4096
    buffer_load_dwordx4 v2, s[8:11], s59 offen offset:0 lds
    buffer_load_dwordx4 v3, s[8:11], s59 offen offset:1024 lds
    buffer_load_dwordx4 v4, s[8:11], s59 offen offset:2048 lds
    buffer_load_dwordx4 v5, s[8:11], s59 offen offset:3072 lds
    s_mov_b32 m0, s47
    s_nop 0
    buffer_load_dwordx4 v6, s[8:11], s59 offen lds
    s_cmp_ge_u32 s40, 3
    s_cbranch_scc1 L_k4_sk_10
    s_add_u32 s47, s57, 94208
    s_mov_b32 m0, s47
    s_add_u32 s59, s58, 1310720
    s_add_u32 s47, s47, 4096
    buffer_load_dwordx4 v2, s[8:11], s59 offen offset:0 lds
    buffer_load_dwordx4 v3, s[8:11], s59 offen offset:1024 lds
    buffer_load_dwordx4 v4, s[8:11], s59 offen offset:2048 lds
    buffer_load_dwordx4 v5, s[8:11], s59 offen offset:3072 lds
    s_mov_b32 m0, s47
    s_nop 0
    buffer_load_dwordx4 v6, s[8:11], s59 offen lds
L_k4_sk_10:
    s_add_u32 s59, s50, 28672
    buffer_load_dwordx4 v[68:71], v7, s[12:15], s59 offen
    s_add_u32 s59, s50, 29696
    buffer_load_dwordx4 v[72:75], v7, s[12:15], s59 offen
    s_add_u32 s59, s50, 30720
    buffer_load_dwordx4 v[76:79], v7, s[12:15], s59 offen
    s_add_u32 s59, s50, 31744
    buffer_load_dwordx4 v[80:83], v7, s[12:15], s59 offen
    s_add_u32 s59, s50, 32768
    buffer_load_dwordx4 v[84:87], v7, s[12:15], s59 offen
    s_add_u32 s59, s50, 33792
    buffer_load_dwordx4 v[88:91], v7, s[12:15], s59 offen
    s_add_u32 s59, s50, 34816
    buffer_load_dwordx4 v[92:95], v7, s[12:15], s59 offen
    ds_read_b64_tr_b16 v[36:37], v8 offset:35840
    ds_read_b64_tr_b16 v[38:39], v8 offset:38400
    ds_read_b64_tr_b16 v[40:41], v8 offset:35872
    ds_read_b64_tr_b16 v[42:43], v8 offset:38432
    ds_read_b64_tr_b16 v[44:45], v8 offset:35904
    ds_read_b64_tr_b16 v[46:47], v8 offset:38464
    ds_read_b64_tr_b16 v[48:49], v8 offset:35936
    ds_read_b64_tr_b16 v[50:51], v8 offset:38496
    ds_read_b64_tr_b16 v[52:53], v8 offset:35968
    ds_read_b64_tr_b16 v[54:55], v8 offset:38528
    ds_read_b64_tr_b16 v[56:57], v9 offset:0
    ds_read_b64_tr_b16 v[58:59], v9 offset:2560
    s_waitcnt lgkmcnt(10)
    ds_read_b64_tr_b16 v[60:61], v9 offset:32
    ds_read_b64_tr_b16 v[62:63], v9 offset:2592
    v_mfma_f32_16x16x32_bf16 v[16:19], v[36:39], v[96:99], v[16:19]
    s_waitcnt lgkmcnt(10)
    ds_read_b64_tr_b16 v[64:65], v9 offset:64
    ds_read_b64_tr_b16 v[66:67], v9 offset:2624
    v_mfma_f32_16x16x32_bf16 v[20:23], v[40:43], v[96:99], v[20:23]
    s_waitcnt lgkmcnt(10)
    ds_read_b64_tr_b16 v[36:37], v9 offset:96
    ds_read_b64_tr_b16 v[38:39], v9 offset:2656
    v_mfma_f32_16x16x32_bf16 v[24:27], v[44:47], v[96:99], v[24:27]
    s_waitcnt lgkmcnt(10)
    ds_read_b64_tr_b16 v[40:41], v9 offset:128
    ds_read_b64_tr_b16 v[42:43], v9 offset:2688
    v_mfma_f32_16x16x32_bf16 v[28:31], v[48:51], v[96:99], v[28:31]
    s_waitcnt lgkmcnt(10)
    ds_read_b64_tr_b16 v[44:45], v9 offset:5120
    ds_read_b64_tr_b16 v[46:47], v9 offset:7680
    v_mfma_f32_16x16x32_bf16 v[32:35], v[52:55], v[96:99], v[32:35]
    s_waitcnt lgkmcnt(10)
    ds_read_b64_tr_b16 v[48:49], v9 offset:5152
    ds_read_b64_tr_b16 v[50:51], v9 offset:7712
    v_mfma_f32_16x16x32_bf16 v[16:19], v[56:59], v[100:103], v[16:19]
    s_waitcnt lgkmcnt(10)
    ds_read_b64_tr_b16 v[52:53], v9 offset:5184
    ds_read_b64_tr_b16 v[54:55], v9 offset:7744
    v_mfma_f32_16x16x32_bf16 v[20:23], v[60:63], v[100:103], v[20:23]
    s_waitcnt lgkmcnt(10)
    ds_read_b64_tr_b16 v[56:57], v9 offset:5216
    ds_read_b64_tr_b16 v[58:59], v9 offset:7776
    v_mfma_f32_16x16x32_bf16 v[24:27], v[64:67], v[100:103], v[24:27]
    s_waitcnt lgkmcnt(10)
    ds_read_b64_tr_b16 v[60:61], v9 offset:5248
    ds_read_b64_tr_b16 v[62:63], v9 offset:7808
    v_mfma_f32_16x16x32_bf16 v[28:31], v[36:39], v[100:103], v[28:31]
    s_waitcnt lgkmcnt(10)
    ds_read_b64_tr_b16 v[64:65], v9 offset:10240
    ds_read_b64_tr_b16 v[66:67], v9 offset:12800
    v_mfma_f32_16x16x32_bf16 v[32:35], v[40:43], v[100:103], v[32:35]
    s_waitcnt lgkmcnt(10)
    ds_read_b64_tr_b16 v[36:37], v9 offset:10272
    ds_read_b64_tr_b16 v[38:39], v9 offset:12832
    v_mfma_f32_16x16x32_bf16 v[16:19], v[44:47], v[104:107], v[16:19]
    s_waitcnt lgkmcnt(10)
    ds_read_b64_tr_b16 v[40:41], v9 offset:10304
    ds_read_b64_tr_b16 v[42:43], v9 offset:12864
    v_mfma_f32_16x16x32_bf16 v[20:23], v[48:51], v[104:107], v[20:23]
    s_waitcnt lgkmcnt(10)
    ds_read_b64_tr_b16 v[44:45], v9 offset:10336
    ds_read_b64_tr_b16 v[46:47], v9 offset:12896
    v_mfma_f32_16x16x32_bf16 v[24:27], v[52:55], v[104:107], v[24:27]
    s_waitcnt lgkmcnt(10)
    ds_read_b64_tr_b16 v[48:49], v9 offset:10368
    ds_read_b64_tr_b16 v[50:51], v9 offset:12928
    v_mfma_f32_16x16x32_bf16 v[28:31], v[56:59], v[104:107], v[28:31]
    s_waitcnt lgkmcnt(10)
    ds_read_b64_tr_b16 v[52:53], v9 offset:15360
    ds_read_b64_tr_b16 v[54:55], v9 offset:17920
    v_mfma_f32_16x16x32_bf16 v[32:35], v[60:63], v[104:107], v[32:35]
    s_waitcnt lgkmcnt(10)
    ds_read_b64_tr_b16 v[56:57], v9 offset:15392
    ds_read_b64_tr_b16 v[58:59], v9 offset:17952
    v_mfma_f32_16x16x32_bf16 v[16:19], v[64:67], v[108:111], v[16:19]
    s_waitcnt lgkmcnt(10)
    ds_read_b64_tr_b16 v[60:61], v9 offset:15424
    ds_read_b64_tr_b16 v[62:63], v9 offset:17984
    v_mfma_f32_16x16x32_bf16 v[20:23], v[36:39], v[108:111], v[20:23]
    s_waitcnt lgkmcnt(10)
    ds_read_b64_tr_b16 v[64:65], v9 offset:15456
    ds_read_b64_tr_b16 v[66:67], v9 offset:18016
    v_mfma_f32_16x16x32_bf16 v[24:27], v[40:43], v[108:111], v[24:27]
    s_waitcnt lgkmcnt(10)
    ds_read_b64_tr_b16 v[36:37], v9 offset:15488
    ds_read_b64_tr_b16 v[38:39], v9 offset:18048
    v_mfma_f32_16x16x32_bf16 v[28:31], v[44:47], v[108:111], v[28:31]
    s_waitcnt lgkmcnt(10)
    ds_read_b64_tr_b16 v[40:41], v9 offset:20480
    ds_read_b64_tr_b16 v[42:43], v9 offset:23040
    v_mfma_f32_16x16x32_bf16 v[32:35], v[48:51], v[108:111], v[32:35]
    s_waitcnt lgkmcnt(10)
    ds_read_b64_tr_b16 v[44:45], v9 offset:20512
    ds_read_b64_tr_b16 v[46:47], v9 offset:23072
    v_mfma_f32_16x16x32_bf16 v[16:19], v[52:55], v[112:115], v[16:19]
    s_waitcnt lgkmcnt(10)
    ds_read_b64_tr_b16 v[48:49], v9 offset:20544
    ds_read_b64_tr_b16 v[50:51], v9 offset:23104
    v_mfma_f32_16x16x32_bf16 v[20:23], v[56:59], v[112:115], v[20:23]
    s_waitcnt lgkmcnt(10)
    ds_read_b64_tr_b16 v[52:53], v9 offset:20576
    ds_read_b64_tr_b16 v[54:55], v9 offset:23136
    v_mfma_f32_16x16x32_bf16 v[24:27], v[60:63], v[112:115], v[24:27]
    s_waitcnt lgkmcnt(10)
    ds_read_b64_tr_b16 v[56:57], v9 offset:20608
    ds_read_b64_tr_b16 v[58:59], v9 offset:23168
    v_mfma_f32_16x16x32_bf16 v[28:31], v[64:67], v[112:115], v[28:31]
    s_waitcnt lgkmcnt(10)
    ds_read_b64_tr_b16 v[60:61], v9 offset:25600
    ds_read_b64_tr_b16 v[62:63], v9 offset:28160
    v_mfma_f32_16x16x32_bf16 v[32:35], v[36:39], v[112:115], v[32:35]
    s_waitcnt lgkmcnt(10)
    ds_read_b64_tr_b16 v[64:65], v9 offset:25632
    ds_read_b64_tr_b16 v[66:67], v9 offset:28192
    v_mfma_f32_16x16x32_bf16 v[16:19], v[40:43], v[116:119], v[16:19]
    s_waitcnt lgkmcnt(10)
    ds_read_b64_tr_b16 v[36:37], v9 offset:25664
    ds_read_b64_tr_b16 v[38:39], v9 offset:28224
    v_mfma_f32_16x16x32_bf16 v[20:23], v[44:47], v[116:119], v[20:23]
    s_waitcnt lgkmcnt(10)
    ds_read_b64_tr_b16 v[40:41], v9 offset:25696
    ds_read_b64_tr_b16 v[42:43], v9 offset:28256
    v_mfma_f32_16x16x32_bf16 v[24:27], v[48:51], v[116:119], v[24:27]
    s_waitcnt lgkmcnt(10)
    ds_read_b64_tr_b16 v[44:45], v9 offset:25728
    ds_read_b64_tr_b16 v[46:47], v9 offset:28288
    v_mfma_f32_16x16x32_bf16 v[28:31], v[52:55], v[116:119], v[28:31]
    s_waitcnt lgkmcnt(10)
    v_mfma_f32_16x16x32_bf16 v[32:35], v[56:59], v[116:119], v[32:35]
    s_waitcnt lgkmcnt(8)
    v_mfma_f32_16x16x32_bf16 v[16:19], v[60:63], v[120:123], v[16:19]
    s_waitcnt lgkmcnt(6)
    v_mfma_f32_16x16x32_bf16 v[20:23], v[64:67], v[120:123], v[20:23]
    s_waitcnt lgkmcnt(4)
    v_mfma_f32_16x16x32_bf16 v[24:27], v[36:39], v[120:123], v[24:27]
    s_waitcnt lgkmcnt(2)
    v_mfma_f32_16x16x32_bf16 v[28:31], v[40:43], v[120:123], v[28:31]
    s_waitcnt lgkmcnt(0)
    v_mfma_f32_16x16x32_bf16 v[32:35], v[44:47], v[120:123], v[32:35]
    s_waitcnt vmcnt(0)
    s_barrier
    s_add_u32 s47, s57, 109568
    s_mov_b32 m0, s47
    s_add_u32 s59, s58, 1433600
    s_add_u32 s47, s47, 4096
    buffer_load_dwordx4 v2, s[8:11], s59 offen offset:0 lds
    buffer_load_dwordx4 v3, s[8:11], s59 offen offset:1024 lds
    buffer_load_dwordx4 v4, s[8:11], s59 offen offset:2048 lds
    buffer_load_dwordx4 v5, s[8:11], s59 offen offset:3072 lds
    s_mov_b32 m0, s47
    s_nop 0
    buffer_load_dwordx4 v6, s[8:11], s59 offen lds
    s_cmp_ge_u32 s40, 3
    s_cbranch_scc1 L_k4_sk_12
    s_add_u32 s47, s57, 130048
    s_mov_b32 m0, s47
    s_add_u32 s59, s58, 1597440
    s_add_u32 s47, s47, 4096
    buffer_load_dwordx4 v2, s[8:11], s59 offen offset:0 lds
    buffer_load_dwordx4 v3, s[8:11], s59 offen offset:1024 lds
    buffer_load_dwordx4 v4, s[8:11], s59 offen offset:2048 lds
    buffer_load_dwordx4 v5, s[8:11], s59 offen offset:3072 lds
    s_mov_b32 m0, s47
    s_nop 0
    buffer_load_dwordx4 v6, s[8:11], s59 offen lds
L_k4_sk_12:
    s_add_u32 s59, s50, 35840
    buffer_load_dwordx4 v[96:99], v7, s[12:15], s59 offen
    s_add_u32 s59, s50, 36864
    buffer_load_dwordx4 v[100:103], v7, s[12:15], s59 offen
    s_add_u32 s59, s50, 37888
    buffer_load_dwordx4 v[104:107], v7, s[12:15], s59 offen
    s_add_u32 s59, s50, 38912
    buffer_load_dwordx4 v[108:111], v7, s[12:15], s59 offen
    s_add_u32 s59, s50, 39936
    buffer_load_dwordx4 v[112:115], v7, s[12:15], s59 offen
    s_add_u32 s59, s50, 40960
    buffer_load_dwordx4 v[116:119], v7, s[12:15], s59 offen
    s_add_u32 s59, s50, 41984
    buffer_load_dwordx4 v[120:123], v7, s[12:15], s59 offen
    ds_read_b64_tr_b16 v[36:37], v8 offset:0
    ds_read_b64_tr_b16 v[38:39], v8 offset:2560
    ds_read_b64_tr_b16 v[40:41], v8 offset:32
    ds_read_b64_tr_b16 v[42:43], v8 offset:2592
    ds_read_b64_tr_b16 v[44:45], v8 offset:64
    ds_read_b64_tr_b16 v[46:47], v8 offset:2624
    ds_read_b64_tr_b16 v[48:49], v8 offset:96
    ds_read_b64_tr_b16 v[50:51], v8 offset:2656
    ds_read_b64_tr_b16 v[52:53], v8 offset:128
    ds_read_b64_tr_b16 v[54:55], v8 offset:2688
    ds_read_b64_tr_b16 v[56:57], v8 offset:5120
    ds_read_b64_tr_b16 v[58:59], v8 offset:7680
    s_waitcnt lgkmcnt(10)
    ds_read_b64_tr_b16 v[60:61], v8 offset:5152
    ds_read_b64_tr_b16 v[62:63], v8 offset:7712
    v_mfma_f32_16x16x32_bf16 v[16:19], v[36:39], v[68:71], v[16:19]
    s_waitcnt lgkmcnt(10)
    ds_read_b64_tr_b16 v[64:65], v8 offset:5184
    ds_read_b64_tr_b16 v[66:67], v8 offset:7744
    v_mfma_f32_16x16x32_bf16 v[20:23], v[40:43], v[68:71], v[20:23]
    s_waitcnt lgkmcnt(10)
    ds_read_b64_tr_b16 v[36:37], v8 offset:5216
    ds_read_b64_tr_b16 v[38:39], v8 offset:7776
    v_mfma_f32_16x16x32_bf16 v[24:27], v[44:47], v[68:71], v[24:27]
    s_waitcnt lgkmcnt(10)
    ds_read_b64_tr_b16 v[40:41], v8 offset:5248
    ds_read_b64_tr_b16 v[42:43], v8 offset:7808
    v_mfma_f32_16x16x32_bf16 v[28:31], v[48:51], v[68:71], v[28:31]
    s_waitcnt lgkmcnt(10)
    ds_read_b64_tr_b16 v[44:45], v8 offset:10240
    ds_read_b64_tr_b16 v[46:47], v8 offset:12800
    v_mfma_f32_16x16x32_bf16 v[32:35], v[52:55], v[68:71], v[32:35]
    s_waitcnt lgkmcnt(10)
    ds_read_b64_tr_b16 v[48:49], v8 offset:10272
    ds_read_b64_tr_b16 v[50:51], v8 offset:12832
    v_mfma_f32_16x16x32_bf16 v[16:19], v[56:59], v[72:75], v[16:19]
    s_waitcnt lgkmcnt(10)
    ds_read_b64_tr_b16 v[52:53], v8 offset:10304
    ds_read_b64_tr_b16 v[54:55], v8 offset:12864
    v_mfma_f32_16x16x32_bf16 v[20:23], v[60:63], v[72:75], v[20:23]
    s_waitcnt lgkmcnt(10)
    ds_read_b64_tr_b16 v[56:57], v8 offset:10336
    ds_read_b64_tr_b16 v[58:59], v8 offset:12896
    v_mfma_f32_16x16x32_bf16 v[24:27], v[64:67], v[72:75], v[24:27]
    s_waitcnt lgkmcnt(10)
    ds_read_b64_tr_b16 v[60:61], v8 offset:10368
    ds_read_b64_tr_b16 v[62:63], v8 offset:12928
    v_mfma_f32_16x16x32_bf16 v[28:31], v[36:39], v[72:75], v[28:31]
    s_waitcnt lgkmcnt(10)
    ds_read_b64_tr_b16 v[64:65], v8 offset:15360
    ds_read_b64_tr_b16 v[66:67], v8 offset:17920
    v_mfma_f32_16x16x32_bf16 v[32:35], v[40:43], v[72:75], v[32:35]
    s_waitcnt lgkmcnt(10)
    ds_read_b64_tr_b16 v[36:37], v8 offset:15392
    ds_read_b64_tr_b16 v[38:39], v8 offset:17952
    v_mfma_f32_16x16x32_bf16 v[16:19], v[44:47], v[76:79], v[16:19]
    s_waitcnt lgkmcnt(10)
    ds_read_b64_tr_b16 v[40:41], v8 offset:15424
    ds_read_b64_tr_b16 v[42:43], v8 offset:17984
    v_mfma_f32_16x16x32_bf16 v[20:23], v[48:51], v[76:79], v[20:23]
    s_waitcnt lgkmcnt(10)
    ds_read_b64_tr_b16 v[44:45], v8 offset:15456
    ds_read_b64_tr_b16 v[46:47], v8 offset:18016
    v_mfma_f32_16x16x32_bf16 v[24:27], v[52:55], v[76:79], v[24:27]
    s_waitcnt lgkmcnt(10)
    ds_read_b64_tr_b16 v[48:49], v8 offset:15488
    ds_read_b64_tr_b16 v[50:51], v8 offset:18048
    v_mfma_f32_16x16x32_bf16 v[28:31], v[56:59], v[76:79], v[28:31]
    s_waitcnt lgkmcnt(10)
    ds_read_b64_tr_b16 v[52:53], v8 offset:20480
    ds_read_b64_tr_b16 v[54:55], v8 offset:23040
    v_mfma_f32_16x16x32_bf16 v[32:35], v[60:63], v[76:79], v[32:35]
    s_waitcnt lgkmcnt(10)
    ds_read_b64_tr_b16 v[56:57], v8 offset:20512
    ds_read_b64_tr_b16 v[58:59], v8 offset:23072
    v_mfma_f32_16x16x32_bf16 v[16:19], v[64:67], v[80:83], v[16:19]
    s_waitcnt lgkmcnt(10)
    ds_read_b64_tr_b16 v[60:61], v8 offset:20544
    ds_read_b64_tr_b16 v[62:63], v8 offset:23104
    v_mfma_f32_16x16x32_bf16 v[20:23], v[36:39], v[80:83], v[20:23]
    s_waitcnt lgkmcnt(10)
    ds_read_b64_tr_b16 v[64:65], v8 offset:20576
    ds_read_b64_tr_b16 v[66:67], v8 offset:23136
    v_mfma_f32_16x16x32_bf16 v[24:27], v[40:43], v[80:83], v[24:27]
    s_waitcnt lgkmcnt(10)
    ds_read_b64_tr_b16 v[36:37], v8 offset:20608
    ds_read_b64_tr_b16 v[38:39], v8 offset:23168
    v_mfma_f32_16x16x32_bf16 v[28:31], v[44:47], v[80:83], v[28:31]
    s_waitcnt lgkmcnt(10)
    ds_read_b64_tr_b16 v[40:41], v8 offset:25600
    ds_read_b64_tr_b16 v[42:43], v8 offset:28160
    v_mfma_f32_16x16x32_bf16 v[32:35], v[48:51], v[80:83], v[32:35]
    s_waitcnt lgkmcnt(10)
    ds_read_b64_tr_b16 v[44:45], v8 offset:25632
    ds_read_b64_tr_b16 v[46:47], v8 offset:28192
    v_mfma_f32_16x16x32_bf16 v[16:19], v[52:55], v[84:87], v[16:19]
    s_waitcnt lgkmcnt(10)
    ds_read_b64_tr_b16 v[48:49], v8 offset:25664
    ds_read_b64_tr_b16 v[50:51], v8 offset:28224
    v_mfma_f32_16x16x32_bf16 v[20:23], v[56:59], v[84:87], v[20:23]
    s_waitcnt lgkmcnt(10)
    ds_read_b64_tr_b16 v[52:53], v8 offset:25696
    ds_read_b64_tr_b16 v[54:55], v8 offset:28256
    v_mfma_f32_16x16x32_bf16 v[24:27], v[60:63], v[84:87], v[24:27]
    s_waitcnt lgkmcnt(10)
    ds_read_b64_tr_b16 v[56:57], v8 offset:25728
    ds_read_b64_tr_b16 v[58:59], v8 offset:28288
    v_mfma_f32_16x16x32_bf16 v[28:31], v[64:67], v[84:87], v[28:31]
    s_waitcnt lgkmcnt(10)
    ds_read_b64_tr_b16 v[60:61], v8 offset:30720
    ds_read_b64_tr_b16 v[62:63], v8 offset:33280
    v_mfma_f32_16x16x32_bf16 v[32:35], v[36:39], v[84:87], v[32:35]
    s_waitcnt lgkmcnt(10)
    ds_read_b64_tr_b16 v[64:65], v8 offset:30752
    ds_read_b64_tr_b16 v[66:67], v8 offset:33312
    v_mfma_f32_16x16x32_bf16 v[16:19], v[40:43], v[88:91], v[16:19]
    s_waitcnt lgkmcnt(10)
    ds_read_b64_tr_b16 v[36:37], v8 offset:30784
    ds_read_b64_tr_b16 v[38:39], v8 offset:33344
    v_mfma_f32_16x16x32_bf16 v[20:23], v[44:47], v[88:91], v[20:23]
    s_waitcnt lgkmcnt(10)
    ds_read_b64_tr_b16 v[40:41], v8 offset:30816
    ds_read_b64_tr_b16 v[42:43], v8 offset:33376
    v_mfma_f32_16x16x32_bf16 v[24:27], v[48:51], v[88:91], v[24:27]
    s_waitcnt lgkmcnt(10)
    ds_read_b64_tr_b16 v[44:45], v8 offset:30848
    ds_read_b64_tr_b16 v[46:47], v8 offset:33408
    v_mfma_f32_16x16x32_bf16 v[28:31], v[52:55], v[88:91], v[28:31]
    s_waitcnt lgkmcnt(10)
    v_mfma_f32_16x16x32_bf16 v[32:35], v[56:59], v[88:91], v[32:35]
    s_waitcnt lgkmcnt(8)
    v_mfma_f32_16x16x32_bf16 v[16:19], v[60:63], v[92:95], v[16:19]
    s_waitcnt lgkmcnt(6)
    v_mfma_f32_16x16x32_bf16 v[20:23], v[64:67], v[92:95], v[20:23]
    s_waitcnt lgkmcnt(4)
    v_mfma_f32_16x16x32_bf16 v[24:27], v[36:39], v[92:95], v[24:27]
    s_waitcnt lgkmcnt(2)
    v_mfma_f32_16x16x32_bf16 v[28:31], v[40:43], v[92:95], v[28:31]
    s_waitcnt lgkmcnt(0)
    v_mfma_f32_16x16x32_bf16 v[32:35], v[44:47], v[92:95], v[32:35]
    s_waitcnt vmcnt(0)
    s_barrier
    s_add_u32 s47, s57, 73728
    s_mov_b32 m0, s47
    s_add_u32 s59, s58, 1720320
    s_add_u32 s47, s47, 4096
    buffer_load_dwordx4 v2, s[8:11], s59 offen offset:0 lds
    buffer_load_dwordx4 v3, s[8:11], s59 offen offset:1024 lds
    buffer_load_dwordx4 v4, s[8:11], s59 offen offset:2048 lds
    buffer_load_dwordx4 v5, s[8:11], s59 offen offset:3072 lds
    s_mov_b32 m0, s47
    s_nop 0
    buffer_load_dwordx4 v6, s[8:11], s59 offen lds
    s_cmp_ge_u32 s40, 2
    s_cbranch_scc1 L_k4_sk_14
    s_add_u32 s47, s57, 94208
    s_mov_b32 m0, s47
    s_add_u32 s59, s58, 1884160
    s_add_u32 s47, s47, 4096
    buffer_load_dwordx4 v2, s[8:11], s59 offen offset:0 lds
    buffer_load_dwordx4 v3, s[8:11], s59 offen offset:1024 lds
    buffer_load_dwordx4 v4, s[8:11], s59 offen offset:2048 lds
    buffer_load_dwordx4 v5, s[8:11], s59 offen offset:3072 lds
    s_mov_b32 m0, s47
    s_nop 0
    buffer_load_dwordx4 v6, s[8:11], s59 offen lds
L_k4_sk_14:
    s_add_u32 s59, s50, 43008
    buffer_load_dwordx4 v[68:71], v7, s[12:15], s59 offen
    s_add_u32 s59, s50, 44032
    buffer_load_dwordx4 v[72:75], v7, s[12:15], s59 offen
    s_add_u32 s59, s50, 45056
    buffer_load_dwordx4 v[76:79], v7, s[12:15], s59 offen
    s_add_u32 s59, s50, 46080
    buffer_load_dwordx4 v[80:83], v7, s[12:15], s59 offen
    s_add_u32 s59, s50, 47104
    buffer_load_dwordx4 v[84:87], v7, s[12:15], s59 offen
    s_add_u32 s59, s50, 48128
    buffer_load_dwordx4 v[88:91], v7, s[12:15], s59 offen
    ds_read_b64_tr_b16 v[36:37], v8 offset:35840
    ds_read_b64_tr_b16 v[38:39], v8 offset:38400
    ds_read_b64_tr_b16 v[40:41], v8 offset:35872
    ds_read_b64_tr_b16 v[42:43], v8 offset:38432
    ds_read_b64_tr_b16 v[44:45], v8 offset:35904
    ds_read_b64_tr_b16 v[46:47], v8 offset:38464
    ds_read_b64_tr_b16 v[48:49], v8 offset:35936
    ds_read_b64_tr_b16 v[50:51], v8 offset:38496
    ds_read_b64_tr_b16 v[52:53], v8 offset:35968
    ds_read_b64_tr_b16 v[54:55], v8 offset:38528
    ds_read_b64_tr_b16 v[56:57], v9 offset:0
    ds_read_b64_tr_b16 v[58:59], v9 offset:2560
    s_waitcnt lgkmcnt(10)
    ds_read_b64_tr_b16 v[60:61], v9 offset:32
    ds_read_b64_tr_b16 v[62:63], v9 offset:2592
    v_mfma_f32_16x16x32_bf16 v[16:19], v[36:39], v[96:99], v[16:19]
    s_waitcnt lgkmcnt(10)
    ds_read_b64_tr_b16 v[64:65], v9 offset:64
    ds_read_b64_tr_b16 v[66:67], v9 offset:2624
    v_mfma_f32_16x16x32_bf16 v[20:23], v[40:43], v[96:99], v[20:23]
    s_waitcnt lgkmcnt(10)
    ds_read_b64_tr_b16 v[36:37], v9 offset:96
    ds_read_b64_tr_b16 v[38:39], v9 offset:2656
    v_mfma_f32_16x16x32_bf16 v[24:27], v[44:47], v[96:99], v[24:27]
    s_waitcnt lgkmcnt(10)
    ds_read_b64_tr_b16 v[40:41], v9 offset:128
    ds_read_b64_tr_b16 v[42:43], v9 offset:2688
    v_mfma_f32_16x16x32_bf16 v[28:31], v[48:51], v[96:99], v[28:31]
    s_waitcnt lgkmcnt(10)
    ds_read_b64_tr_b16 v[44:45], v9 offset:5120
    ds_read_b64_tr_b16 v[46:47], v9 offset:7680
    v_mfma_f32_16x16x32_bf16 v[32:35], v[52:55], v[96:99], v[32:35]
    s_waitcnt lgkmcnt(10)
    ds_read_b64_tr_b16 v[48:49], v9 offset:5152
    ds_read_b64_tr_b16 v[50:51], v9 offset:7712
    v_mfma_f32_16x16x32_bf16 v[16:19], v[56:59], v[100:103], v[16:19]
    s_waitcnt lgkmcnt(10)
    ds_read_b64_tr_b16 v[52:53], v9 offset:5184
    ds_read_b64_tr_b16 v[54:55], v9 offset:7744
    v_mfma_f32_16x16x32_bf16 v[20:23], v[60:63], v[100:103], v[20:23]
    s_waitcnt lgkmcnt(10)
    ds_read_b64_tr_b16 v[56:57], v9 offset:5216
    ds_read_b64_tr_b16 v[58:59], v9 offset:7776
    v_mfma_f32_16x16x32_bf16 v[24:27], v[64:67], v[100:103], v[24:27]
    s_waitcnt lgkmcnt(10)
    ds_read_b64_tr_b16 v[60:61], v9 offset:5248
    ds_read_b64_tr_b16 v[62:63], v9 offset:7808
    v_mfma_f32_16x16x32_bf16 v[28:31], v[36:39], v[100:103], v[28:31]
    s_waitcnt lgkmcnt(10)
    ds_read_b64_tr_b16 v[64:65], v9 offset:10240
    ds_read_b64_tr_b16 v[66:67], v9 offset:12800
    v_mfma_f32_16x16x32_bf16 v[32:35], v[40:43], v[100:103], v[32:35]
    s_waitcnt lgkmcnt(10)
    ds_read_b64_tr_b16 v[36:37], v9 offset:10272
    ds_read_b64_tr_b16 v[38:39], v9 offset:12832
    v_mfma_f32_16x16x32_bf16 v[16:19], v[44:47], v[104:107], v[16:19]
    s_waitcnt lgkmcnt(10)
    ds_read_b64_tr_b16 v[40:41], v9 offset:10304
    ds_read_b64_tr_b16 v[42:43], v9 offset:12864
    v_mfma_f32_16x16x32_bf16 v[20:23], v[48:51], v[104:107], v[20:23]
    s_waitcnt lgkmcnt(10)
    ds_read_b64_tr_b16 v[44:45], v9 offset:10336
    ds_read_b64_tr_b16 v[46:47], v9 offset:12896
    v_mfma_f32_16x16x32_bf16 v[24:27], v[52:55], v[104:107], v[24:27]
    s_waitcnt lgkmcnt(10)
    ds_read_b64_tr_b16 v[48:49], v9 offset:10368
    ds_read_b64_tr_b16 v[50:51], v9 offset:12928
    v_mfma_f32_16x16x32_bf16 v[28:31], v[56:59], v[104:107], v[28:31]
    s_waitcnt lgkmcnt(10)
    ds_read_b64_tr_b16 v[52:53], v9 offset:15360
    ds_read_b64_tr_b16 v[54:55], v9 offset:17920
    v_mfma_f32_16x16x32_bf16 v[32:35], v[60:63], v[104:107], v[32:35]
    s_waitcnt lgkmcnt(10)
    ds_read_b64_tr_b16 v[56:57], v9 offset:15392
    ds_read_b64_tr_b16 v[58:59], v9 offset:17952
    v_mfma_f32_16x16x32_bf16 v[16:19], v[64:67], v[108:111], v[16:19]
    s_waitcnt lgkmcnt(10)
    ds_read_b64_tr_b16 v[60:61], v9 offset:15424
    ds_read_b64_tr_b16 v[62:63], v9 offset:17984
    v_mfma_f32_16x16x32_bf16 v[20:23], v[36:39], v[108:111], v[20:23]
    s_waitcnt lgkmcnt(10)
    ds_read_b64_tr_b16 v[64:65], v9 offset:15456
    ds_read_b64_tr_b16 v[66:67], v9 offset:18016
    v_mfma_f32_16x16x32_bf16 v[24:27], v[40:43], v[108:111], v[24:27]
    s_waitcnt lgkmcnt(10)
    ds_read_b64_tr_b16 v[36:37], v9 offset:15488
    ds_read_b64_tr_b16 v[38:39], v9 offset:18048
    v_mfma_f32_16x16x32_bf16 v[28:31], v[44:47], v[108:111], v[28:31]
    s_waitcnt lgkmcnt(10)
    ds_read_b64_tr_b16 v[40:41], v9 offset:20480
    ds_read_b64_tr_b16 v[42:43], v9 offset:23040
    v_mfma_f32_16x16x32_bf16 v[32:35], v[48:51], v[108:111], v[32:35]
    s_waitcnt lgkmcnt(10)
    ds_read_b64_tr_b16 v[44:45], v9 offset:20512
    ds_read_b64_tr_b16 v[46:47], v9 offset:23072
    v_mfma_f32_16x16x32_bf16 v[16:19], v[52:55], v[112:115], v[16:19]
    s_waitcnt lgkmcnt(10)
    ds_read_b64_tr_b16 v[48:49], v9 offset:20544
    ds_read_b64_tr_b16 v[50:51], v9 offset:23104
    v_mfma_f32_16x16x32_bf16 v[20:23], v[56:59], v[112:115], v[20:23]
    s_waitcnt lgkmcnt(10)
    ds_read_b64_tr_b16 v[52:53], v9 offset:20576
    ds_read_b64_tr_b16 v[54:55], v9 offset:23136
    v_mfma_f32_16x16x32_bf16 v[24:27], v[60:63], v[112:115], v[24:27]
    s_waitcnt lgkmcnt(10)
    ds_read_b64_tr_b16 v[56:57], v9 offset:20608
    ds_read_b64_tr_b16 v[58:59], v9 offset:23168
    v_mfma_f32_16x16x32_bf16 v[28:31], v[64:67], v[112:115], v[28:31]
    s_waitcnt lgkmcnt(10)
    ds_read_b64_tr_b16 v[60:61], v9 offset:25600
    ds_read_b64_tr_b16 v[62:63], v9 offset:28160
    v_mfma_f32_16x16x32_bf16 v[32:35], v[36:39], v[112:115], v[32:35]
    s_waitcnt lgkmcnt(10)
    ds_read_b64_tr_b16 v[64:65], v9 offset:25632
    ds_read_b64_tr_b16 v[66:67], v9 offset:28192
    v_mfma_f32_16x16x32_bf16 v[16:19], v[40:43], v[116:119], v[16:19]
    s_waitcnt lgkmcnt(10)
    ds_read_b64_tr_b16 v[36:37], v9 offset:25664
    ds_read_b64_tr_b16 v[38:39], v9 offset:28224
    v_mfma_f32_16x16x32_bf16 v[20:23], v[44:47], v[116:119], v[20:23]
    s_waitcnt lgkmcnt(10)
    ds_read_b64_tr_b16 v[40:41], v9 offset:25696
    ds_read_b64_tr_b16 v[42:43], v9 offset:28256
    v_mfma_f32_16x16x32_bf16 v[24:27], v[48:51], v[116:119], v[24:27]
    s_waitcnt lgkmcnt(10)
    ds_read_b64_tr_b16 v[44:45], v9 offset:25728
    ds_read_b64_tr_b16 v[46:47], v9 offset:28288
    v_mfma_f32_16x16x32_bf16 v[28:31], v[52:55], v[116:119], v[28:31]
    s_waitcnt lgkmcnt(10)
    v_mfma_f32_16x16x32_bf16 v[32:35], v[56:59], v[116:119], v[32:35]
    s_waitcnt lgkmcnt(8)
    v_mfma_f32_16x16x32_bf16 v[16:19], v[60:63], v[120:123], v[16:19]
    s_waitcnt lgkmcnt(6)
    v_mfma_f32_16x16x32_bf16 v[20:23], v[64:67], v[120:123], v[20:23]
    s_waitcnt lgkmcnt(4)
    v_mfma_f32_16x16x32_bf16 v[24:27], v[36:39], v[120:123], v[24:27]
    s_waitcnt lgkmcnt(2)
    v_mfma_f32_16x16x32_bf16 v[28:31], v[40:43], v[120:123], v[28:31]
    s_waitcnt lgkmcnt(0)
    v_mfma_f32_16x16x32_bf16 v[32:35], v[44:47], v[120:123], v[32:35]
    s_waitcnt vmcnt(0)
    s_barrier
    s_add_u32 s47, s57, 104448
    s_mov_b32 m0, s47
    s_add_u32 s59, s58, 0
    s_add_u32 s47, s47, 4096
    buffer_load_dwordx4 v2, s[20:23], s59 offen offset:0 lds
    buffer_load_dwordx4 v3, s[20:23], s59 offen offset:1024 lds
    buffer_load_dwordx4 v4, s[20:23], s59 offen offset:2048 lds
    buffer_load_dwordx4 v5, s[20:23], s59 offen offset:3072 lds
    s_mov_b32 m0, s47
    s_nop 0
    buffer_load_dwordx4 v6, s[20:23], s59 offen lds
    s_add_u32 s47, s57, 124928
    s_mov_b32 m0, s47
    s_add_u32 s59, s58, 163840
    s_add_u32 s47, s47, 4096
    buffer_load_dwordx4 v2, s[20:23], s59 offen offset:0 lds
    buffer_load_dwordx4 v3, s[20:23], s59 offen offset:1024 lds
    buffer_load_dwordx4 v4, s[20:23], s59 offen offset:2048 lds
    buffer_load_dwordx4 v5, s[20:23], s59 offen offset:3072 lds
    s_mov_b32 m0, s47
    s_nop 0
    buffer_load_dwordx4 v6, s[20:23], s59 offen lds
    s_cmp_ge_u32 s40, 2
    s_cbranch_scc1 L_k4_sk_17
    s_add_u32 s47, s57, 145408
    s_mov_b32 m0, s47
    s_add_u32 s59, s58, 327680
    s_add_u32 s47, s47, 4096
    buffer_load_dwordx4 v2, s[20:23], s59 offen offset:0 lds
    buffer_load_dwordx4 v3, s[20:23], s59 offen offset:1024 lds
    buffer_load_dwordx4 v4, s[20:23], s59 offen offset:2048 lds
    buffer_load_dwordx4 v5, s[20:23], s59 offen offset:3072 lds
    s_mov_b32 m0, s47
    s_nop 0
    buffer_load_dwordx4 v6, s[20:23], s59 offen lds
L_k4_sk_17:
    buffer_load_dwordx2 v[148:149], v10, s[28:31], 0 offen offset:0
    buffer_load_dwordx2 v[158:159], v11, s[36:39], 0 offen offset:0
    buffer_load_dwordx2 v[150:151], v10, s[28:31], 0 offen offset:32
    buffer_load_dwordx2 v[160:161], v11, s[36:39], 0 offen offset:32
    buffer_load_dwordx2 v[152:153], v10, s[28:31], 0 offen offset:64
    buffer_load_dwordx2 v[162:163], v11, s[36:39], 0 offen offset:64
    buffer_load_dwordx2 v[154:155], v10, s[28:31], 0 offen offset:96
    buffer_load_dwordx2 v[164:165], v11, s[36:39], 0 offen offset:96
    buffer_load_dwordx2 v[156:157], v10, s[28:31], 0 offen offset:128
    buffer_load_dwordx2 v[166:167], v11, s[36:39], 0 offen offset:128
    ds_read_b64_tr_b16 v[36:37], v8 offset:0
    ds_read_b64_tr_b16 v[38:39], v8 offset:2560
    ds_read_b64_tr_b16 v[40:41], v8 offset:32
    ds_read_b64_tr_b16 v[42:43], v8 offset:2592
    ds_read_b64_tr_b16 v[44:45], v8 offset:64
    ds_read_b64_tr_b16 v[46:47], v8 offset:2624
    ds_read_b64_tr_b16 v[48:49], v8 offset:96
    ds_read_b64_tr_b16 v[50:51], v8 offset:2656
    ds_read_b64_tr_b16 v[52:53], v8 offset:128
    ds_read_b64_tr_b16 v[54:55], v8 offset:2688
    ds_read_b64_tr_b16 v[56:57], v8 offset:5120
    ds_read_b64_tr_b16 v[58:59], v8 offset:7680
    s_waitcnt lgkmcnt(10)
    ds_read_b64_tr_b16 v[60:61], v8 offset:5152
    ds_read_b64_tr_b16 v[62:63], v8 offset:7712
    v_mfma_f32_16x16x32_bf16 v[16:19], v[36:39], v[68:71], v[16:19]
    s_waitcnt lgkmcnt(10)
    ds_read_b64_tr_b16 v[64:65], v8 offset:5184
    ds_read_b64_tr_b16 v[66:67], v8 offset:7744
    v_mfma_f32_16x16x32_bf16 v[20:23], v[40:43], v[68:71], v[20:23]
    s_waitcnt lgkmcnt(10)
    ds_read_b64_tr_b16 v[36:37], v8 offset:5216
    ds_read_b64_tr_b16 v[38:39], v8 offset:7776
    v_mfma_f32_16x16x32_bf16 v[24:27], v[44:47], v[68:71], v[24:27]
    s_waitcnt lgkmcnt(10)
    ds_read_b64_tr_b16 v[40:41], v8 offset:5248
    ds_read_b64_tr_b16 v[42:43], v8 offset:7808
    v_mfma_f32_16x16x32_bf16 v[28:31], v[48:51], v[68:71], v[28:31]
    s_waitcnt lgkmcnt(10)
    ds_read_b64_tr_b16 v[44:45], v8 offset:10240
    ds_read_b64_tr_b16 v[46:47], v8 offset:12800
    v_mfma_f32_16x16x32_bf16 v[32:35], v[52:55], v[68:71], v[32:35]
    s_waitcnt lgkmcnt(10)
    ds_read_b64_tr_b16 v[48:49], v8 offset:10272
    ds_read_b64_tr_b16 v[50:51], v8 offset:12832
    v_mfma_f32_16x16x32_bf16 v[16:19], v[56:59], v[72:75], v[16:19]
    s_waitcnt lgkmcnt(10)
    ds_read_b64_tr_b16 v[52:53], v8 offset:10304
    ds_read_b64_tr_b16 v[54:55], v8 offset:12864
    v_mfma_f32_16x16x32_bf16 v[20:23], v[60:63], v[72:75], v[20:23]
    s_waitcnt lgkmcnt(10)
    ds_read_b64_tr_b16 v[56:57], v8 offset:10336
    ds_read_b64_tr_b16 v[58:59], v8 offset:12896
    v_mfma_f32_16x16x32_bf16 v[24:27], v[64:67], v[72:75], v[24:27]
    s_waitcnt lgkmcnt(10)
    ds_read_b64_tr_b16 v[60:61], v8 offset:10368
    ds_read_b64_tr_b16 v[62:63], v8 offset:12928
    v_mfma_f32_16x16x32_bf16 v[28:31], v[36:39], v[72:75], v[28:31]
    s_waitcnt lgkmcnt(10)
    ds_read_b64_tr_b16 v[64:65], v8 offset:15360
    ds_read_b64_tr_b16 v[66:67], v8 offset:17920
    v_mfma_f32_16x16x32_bf16 v[32:35], v[40:43], v[72:75], v[32:35]
    s_waitcnt lgkmcnt(10)
    ds_read_b64_tr_b16 v[36:37], v8 offset:15392
    ds_read_b64_tr_b16 v[38:39], v8 offset:17952
    v_mfma_f32_16x16x32_bf16 v[16:19], v[44:47], v[76:79], v[16:19]
    s_waitcnt lgkmcnt(10)
    ds_read_b64_tr_b16 v[40:41], v8 offset:15424
    ds_read_b64_tr_b16 v[42:43], v8 offset:17984
    v_mfma_f32_16x16x32_bf16 v[20:23], v[48:51], v[76:79], v[20:23]
    s_waitcnt lgkmcnt(10)
    ds_read_b64_tr_b16 v[44:45], v8 offset:15456
    ds_read_b64_tr_b16 v[46:47], v8 offset:18016
    v_mfma_f32_16x16x32_bf16 v[24:27], v[52:55], v[76:79], v[24:27]
    s_waitcnt lgkmcnt(10)
    ds_read_b64_tr_b16 v[48:49], v8 offset:15488
    ds_read_b64_tr_b16 v[50:51], v8 offset:18048
    v_mfma_f32_16x16x32_bf16 v[28:31], v[56:59], v[76:79], v[28:31]
    s_waitcnt lgkmcnt(10)
    ds_read_b64_tr_b16 v[52:53], v8 offset:20480
    ds_read_b64_tr_b16 v[54:55], v8 offset:23040
    v_mfma_f32_16x16x32_bf16 v[32:35], v[60:63], v[76:79], v[32:35]
    s_waitcnt lgkmcnt(10)
    ds_read_b64_tr_b16 v[56:57], v8 offset:20512
    ds_read_b64_tr_b16 v[58:59], v8 offset:23072
    v_mfma_f32_16x16x32_bf16 v[16:19], v[64:67], v[80:83], v[16:19]
    s_waitcnt lgkmcnt(10)
    ds_read_b64_tr_b16 v[60:61], v8 offset:20544
    ds_read_b64_tr_b16 v[62:63], v8 offset:23104
    v_mfma_f32_16x16x32_bf16 v[20:23], v[36:39], v[80:83], v[20:23]
    s_waitcnt lgkmcnt(10)
    ds_read_b64_tr_b16 v[64:65], v8 offset:20576
    ds_read_b64_tr_b16 v[66:67], v8 offset:23136
    v_mfma_f32_16x16x32_bf16 v[24:27], v[40:43], v[80:83], v[24:27]
    s_waitcnt lgkmcnt(10)
    ds_read_b64_tr_b16 v[36:37], v8 offset:20608
    ds_read_b64_tr_b16 v[38:39], v8 offset:23168
    v_mfma_f32_16x16x32_bf16 v[28:31], v[44:47], v[80:83], v[28:31]
    s_waitcnt lgkmcnt(10)
    ds_read_b64_tr_b16 v[40:41], v8 offset:25600
    ds_read_b64_tr_b16 v[42:43], v8 offset:28160
    v_mfma_f32_16x16x32_bf16 v[32:35], v[48:51], v[80:83], v[32:35]
    s_waitcnt lgkmcnt(10)
    ds_read_b64_tr_b16 v[44:45], v8 offset:25632
    ds_read_b64_tr_b16 v[46:47], v8 offset:28192
    v_mfma_f32_16x16x32_bf16 v[16:19], v[52:55], v[84:87], v[16:19]
    s_waitcnt lgkmcnt(10)
    ds_read_b64_tr_b16 v[48:49], v8 offset:25664
    ds_read_b64_tr_b16 v[50:51], v8 offset:28224
    v_mfma_f32_16x16x32_bf16 v[20:23], v[56:59], v[84:87], v[20:23]
    s_waitcnt lgkmcnt(10)
    ds_read_b64_tr_b16 v[52:53], v8 offset:25696
    ds_read_b64_tr_b16 v[54:55], v8 offset:28256
    v_mfma_f32_16x16x32_bf16 v[24:27], v[60:63], v[84:87], v[24:27]
    s_waitcnt lgkmcnt(10)
    ds_read_b64_tr_b16 v[56:57], v8 offset:25728
    ds_read_b64_tr_b16 v[58:59], v8 offset:28288
    v_mfma_f32_16x16x32_bf16 v[28:31], v[64:67], v[84:87], v[28:31]
    s_waitcnt lgkmcnt(10)
    v_mfma_f32_16x16x32_bf16 v[32:35], v[36:39], v[84:87], v[32:35]
    s_waitcnt lgkmcnt(8)
    v_mfma_f32_16x16x32_bf16 v[16:19], v[40:43], v[88:91], v[16:19]
    s_waitcnt lgkmcnt(6)
    v_mfma_f32_16x16x32_bf16 v[20:23], v[44:47], v[88:91], v[20:23]
    s_waitcnt lgkmcnt(4)
    v_mfma_f32_16x16x32_bf16 v[24:27], v[48:51], v[88:91], v[24:27]
    s_waitcnt lgkmcnt(2)
    v_mfma_f32_16x16x32_bf16 v[28:31], v[52:55], v[88:91], v[28:31]
    s_waitcnt lgkmcnt(0)
    v_mfma_f32_16x16x32_bf16 v[32:35], v[56:59], v[88:91], v[32:35]
    s_waitcnt vmcnt(0)
    s_barrier
    s_add_u32 s47, s57, 73728
    s_mov_b32 m0, s47
    s_add_u32 s59, s58, 409600
    s_add_u32 s47, s47, 4096
    buffer_load_dwordx4 v2, s[20:23], s59 offen offset:0 lds
    buffer_load_dwordx4 v3, s[20:23], s59 offen offset:1024 lds
    buffer_load_dwordx4 v4, s[20:23], s59 offen offset:2048 lds
    buffer_load_dwordx4 v5, s[20:23], s59 offen offset:3072 lds
    s_mov_b32 m0, s47
    s_nop 0
    buffer_load_dwordx4 v6, s[20:23], s59 offen lds
    s_cmp_ge_u32 s40, 2
    s_cbranch_scc1 L_k4_sk_19
    s_add_u32 s47, s57, 94208
    s_mov_b32 m0, s47
    s_add_u32 s59, s58, 573440
    s_add_u32 s47, s47, 4096
    buffer_load_dwordx4 v2, s[20:23], s59 offen offset:0 lds
    buffer_load_dwordx4 v3, s[20:23], s59 offen offset:1024 lds
    buffer_load_dwordx4 v4, s[20:23], s59 offen offset:2048 lds
    buffer_load_dwordx4 v5, s[20:23], s59 offen offset:3072 lds
    s_mov_b32 m0, s47
    s_nop 0
    buffer_load_dwordx4 v6, s[20:23], s59 offen lds
L_k4_sk_19:
    s_add_u32 s47, s57, 49152
    s_mov_b32 m0, s47
    s_add_u32 s59, s58, 655360
    s_add_u32 s47, s47, 4096
    buffer_load_dwordx4 v2, s[20:23], s59 offen offset:0 lds
    buffer_load_dwordx4 v3, s[20:23], s59 offen offset:1024 lds
    buffer_load_dwordx4 v4, s[20:23], s59 offen offset:2048 lds
    buffer_load_dwordx4 v5, s[20:23], s59 offen offset:3072 lds
    s_mov_b32 m0, s47
    s_nop 0
    buffer_load_dwordx4 v6, s[20:23], s59 offen lds
    s_barrier
    v_lshlrev_b32 v12, 16, v148
    v_and_b32 v13, 0xffff0000, v148
    v_add_f32 v16, v16, v12
    v_add_f32 v17, v17, v13
    v_lshlrev_b32 v12, 16, v158
    v_and_b32 v13, 0xffff0000, v158
    v_add_f32 v16, v16, v12
    v_add_f32 v17, v17, v13
    v_lshlrev_b32 v12, 16, v149
    v_and_b32 v13, 0xffff0000, v149
    v_add_f32 v18, v18, v12
    v_add_f32 v19, v19, v13
    v_lshlrev_b32 v12, 16, v159
    v_and_b32 v13, 0xffff0000, v159
    v_add_f32 v18, v18, v12
    v_add_f32 v19, v19, v13
    v_lshlrev_b32 v12, 16, v150
    v_and_b32 v13, 0xffff0000, v150
    v_add_f32 v20, v20, v12
    v_add_f32 v21, v21, v13
    v_lshlrev_b32 v12, 16, v160
    v_and_b32 v13, 0xffff0000, v160
    v_add_f32 v20, v20, v12
    v_add_f32 v21, v21, v13
    v_lshlrev_b32 v12, 16, v151
    v_and_b32 v13, 0xffff0000, v151
    v_add_f32 v22, v22, v12
    v_add_f32 v23, v23, v13
    v_lshlrev_b32 v12, 16, v161
    v_and_b32 v13, 0xffff0000, v161
    v_add_f32 v22, v22, v12
    v_add_f32 v23, v23, v13
    v_lshlrev_b32 v12, 16, v152
    v_and_b32 v13, 0xffff0000, v152
    v_add_f32 v24, v24, v12
    v_add_f32 v25, v25, v13
    v_lshlrev_b32 v12, 16, v162
    v_and_b32 v13, 0xffff0000, v162
    v_add_f32 v24, v24, v12
    v_add_f32 v25, v25, v13
    v_lshlrev_b32 v12, 16, v153
    v_and_b32 v13, 0xffff0000, v153
    v_add_f32 v26, v26, v12
    v_add_f32 v27, v27, v13
    v_lshlrev_b32 v12, 16, v163
    v_and_b32 v13, 0xffff0000, v163
    v_add_f32 v26, v26, v12
    v_add_f32 v27, v27, v13
    v_lshlrev_b32 v12, 16, v154
    v_and_b32 v13, 0xffff0000, v154
    v_add_f32 v28, v28, v12
    v_add_f32 v29, v29, v13
    v_lshlrev_b32 v12, 16, v164
    v_and_b32 v13, 0xffff0000, v164
    v_add_f32 v28, v28, v12
    v_add_f32 v29, v29, v13
    v_lshlrev_b32 v12, 16, v155
    v_and_b32 v13, 0xffff0000, v155
    v_add_f32 v30, v30, v12
    v_add_f32 v31, v31, v13
    v_lshlrev_b32 v12, 16, v165
    v_and_b32 v13, 0xffff0000, v165
    v_add_f32 v30, v30, v12
    v_add_f32 v31, v31, v13
    v_lshlrev_b32 v12, 16, v156
    v_and_b32 v13, 0xffff0000, v156
    v_add_f32 v32, v32, v12
    v_add_f32 v33, v33, v13
    v_lshlrev_b32 v12, 16, v166
    v_and_b32 v13, 0xffff0000, v166
    v_add_f32 v32, v32, v12
    v_add_f32 v33, v33, v13
    v_lshlrev_b32 v12, 16, v157
    v_and_b32 v13, 0xffff0000, v157
    v_add_f32 v34, v34, v12
    v_add_f32 v35, v35, v13
    v_lshlrev_b32 v12, 16, v167
    v_and_b32 v13, 0xffff0000, v167
    v_add_f32 v34, v34, v12
    v_add_f32 v35, v35, v13
    s_barrier
    s_lshr_b32 s47, s41, 2
    s_lshl_b32 s47, s47, 10
    v_mov_b32 v12, s47
    s_mov_b32 s57, 0
    s_cmp_lg_u32 s40, 0
    s_cbranch_scc1 L_k4_go
L_k4_poll:
    buffer_load_dword v13, v12, s[60:63], 0 offen sc1
    s_waitcnt vmcnt(0)
    v_readfirstlane_b32 s58, v13
    s_add_u32 s57, s57, 1
    s_cmp_ge_u32 s58, 32
    s_cbranch_scc1 L_k4_go
    s_sleep 1
    s_cmp_lt_u32 s57, 0x40000
    s_cbranch_scc1 L_k4_poll
L_k4_go:
    s_waitcnt vmcnt(0)
    s_barrier
    buffer_load_dwordx4 v[68:71], v7, s[12:15], s44 offen offset:0 sc1
    buffer_load_dwordx4 v[72:75], v7, s[12:15], s44 offen offset:1024 sc1
    buffer_load_dwordx4 v[76:79], v7, s[12:15], s44 offen offset:2048 sc1
    buffer_load_dwordx4 v[80:83], v7, s[12:15], s44 offen offset:3072 sc1
    s_add_u32 s44, s44, 4096
    buffer_load_dwordx4 v[84:87], v7, s[12:15], s44 offen offset:0 sc1
    buffer_load_dwordx4 v[88:91], v7, s[12:15], s44 offen offset:1024 sc1
    buffer_load_dwordx4 v[92:95], v7, s[12:15], s44 offen offset:2048 sc1
    buffer_load_dwordx4 v[96:99], v7, s[12:15], s44 offen offset:3072 sc1
    s_add_u32 s44, s44, 4096
    buffer_load_dwordx4 v[100:103], v7, s[12:15], s44 offen offset:0 sc1
    buffer_load_dwordx4 v[104:107], v7, s[12:15], s44 offen offset:1024 sc1
    buffer_load_dwordx4 v[108:111], v7, s[12:15], s44 offen offset:2048 sc1
    buffer_load_dwordx4 v[112:115], v7, s[12:15], s44 offen offset:3072 sc1
    s_add_u32 s44, s44, 4096
    buffer_load_dwordx4 v[116:119], v7, s[12:15], s44 offen offset:0 sc1
    buffer_load_dwordx4 v[120:123], v7, s[12:15], s44 offen offset:1024 sc1
    buffer_load_dwordx4 v[124:127], v7, s[12:15], s44 offen offset:2048 sc1
    buffer_load_dwordx4 v[128:131], v7, s[12:15], s44 offen offset:3072 sc1
    s_add_u32 s44, s44, 4096
    buffer_load_dwordx4 v[132:135], v7, s[12:15], s44 offen offset:0 sc1
    buffer_load_dwordx4 v[136:139], v7, s[12:15], s44 offen offset:1024 sc1
    buffer_load_dwordx4 v[140:143], v7, s[12:15], s44 offen offset:2048 sc1
    buffer_load_dwordx4 v[144:147], v7, s[12:15], s44 offen offset:3072 sc1
    ds_read_b64_tr_b16 v[36:37], v8 offset:30720
    ds_read_b64_tr_b16 v[38:39], v8 offset:33280
    ds_read_b64_tr_b16 v[40:41], v8 offset:30752
    ds_read_b64_tr_b16 v[42:43], v8 offset:33312
    ds_read_b64_tr_b16 v[44:45], v8 offset:30784
    ds_read_b64_tr_b16 v[46:47], v8 offset:33344
    ds_read_b64_tr_b16 v[48:49], v8 offset:30816
    ds_read_b64_tr_b16 v[50:51], v8 offset:33376
    ds_read_b64_tr_b16 v[52:53], v8 offset:30848
    ds_read_b64_tr_b16 v[54:55], v8 offset:33408
    ds_read_b64_tr_b16 v[56:57], v8 offset:35840
    ds_read_b64_tr_b16 v[58:59], v8 offset:38400
    s_waitcnt vmcnt(19) lgkmcnt(10)
    ds_read_b64_tr_b16 v[60:61], v8 offset:35872
    ds_read_b64_tr_b16 v[62:63], v8 offset:38432
    v_mfma_f32_16x16x32_bf16 v[16:19], v[36:39], v[68:71], v[16:19]
    s_waitcnt lgkmcnt(10)
    ds_read_b64_tr_b16 v[64:65], v8 offset:35904
    ds_read_b64_tr_b16 v[66:67], v8 offset:38464
    v_mfma_f32_16x16x32_bf16 v[20:23], v[40:43], v[68:71], v[20:23]
    s_waitcnt lgkmcnt(10)
    ds_read_b64_tr_b16 v[36:37], v8 offset:35936
    ds_read_b64_tr_b16 v[38:39], v8 offset:38496
    v_mfma_f32_16x16x32_bf16 v[24:27], v[44:47], v[68:71], v[24:27]
    s_waitcnt lgkmcnt(10)
    ds_read_b64_tr_b16 v[40:41], v8 offset:35968
    ds_read_b64_tr_b16 v[42:43], v8 offset:38528
    v_mfma_f32_16x16x32_bf16 v[28:31], v[48:51], v[68:71], v[28:31]
    s_waitcnt lgkmcnt(10)
    ds_read_b64_tr_b16 v[44:45], v9 offset:0
    ds_read_b64_tr_b16 v[46:47], v9 offset:2560
    v_mfma_f32_16x16x32_bf16 v[32:35], v[52:55], v[68:71], v[32:35]
    s_waitcnt vmcnt(18) lgkmcnt(10)
    ds_read_b64_tr_b16 v[48:49], v9 offset:32
    ds_read_b64_tr_b16 v[50:51], v9 offset:2592
    v_mfma_f32_16x16x32_bf16 v[16:19], v[56:59], v[72:75], v[16:19]
    s_waitcnt lgkmcnt(10)
    ds_read_b64_tr_b16 v[52:53], v9 offset:64
    ds_read_b64_tr_b16 v[54:55], v9 offset:2624
    v_mfma_f32_16x16x32_bf16 v[20:23], v[60:63], v[72:75], v[20:23]
    s_waitcnt lgkmcnt(10)
    ds_read_b64_tr_b16 v[56:57], v9 offset:96
    ds_read_b64_tr_b16 v[58:59], v9 offset:2656
    v_mfma_f32_16x16x32_bf16 v[24:27], v[64:67], v[72:75], v[24:27]
    s_waitcnt lgkmcnt(10)
    ds_read_b64_tr_b16 v[60:61], v9 offset:128
    ds_read_b64_tr_b16 v[62:63], v9 offset:2688
    v_mfma_f32_16x16x32_bf16 v[28:31], v[36:39], v[72:75], v[28:31]
    s_waitcnt lgkmcnt(10)
    ds_read_b64_tr_b16 v[64:65], v9 offset:5120
    ds_read_b64_tr_b16 v[66:67], v9 offset:7680
    v_mfma_f32_16x16x32_bf16 v[32:35], v[40:43], v[72:75], v[32:35]
    s_waitcnt vmcnt(17) lgkmcnt(10)
    ds_read_b64_tr_b16 v[36:37], v9 offset:5152
    ds_read_b64_tr_b16 v[38:39], v9 offset:7712
    v_mfma_f32_16x16x32_bf16 v[16:19], v[44:47], v[76:79], v[16:19]
    s_waitcnt lgkmcnt(10)
    ds_read_b64_tr_b16 v[40:41], v9 offset:5184
    ds_read_b64_tr_b16 v[42:43], v9 offset:7744
    v_mfma_f32_16x16x32_bf16 v[20:23], v[48:51], v[76:79], v[20:23]
    s_waitcnt lgkmcnt(10)
    ds_read_b64_tr_b16 v[44:45], v9 offset:5216
    ds_read_b64_tr_b16 v[46:47], v9 offset:7776
    v_mfma_f32_16x16x32_bf16 v[24:27], v[52:55], v[76:79], v[24:27]
    s_waitcnt lgkmcnt(10)
    ds_read_b64_tr_b16 v[48:49], v9 offset:5248
    ds_read_b64_tr_b16 v[50:51], v9 offset:7808
    v_mfma_f32_16x16x32_bf16 v[28:31], v[56:59], v[76:79], v[28:31]
    s_waitcnt lgkmcnt(10)
    ds_read_b64_tr_b16 v[52:53], v9 offset:10240
    ds_read_b64_tr_b16 v[54:55], v9 offset:12800
    v_mfma_f32_16x16x32_bf16 v[32:35], v[60:63], v[76:79], v[32:35]
    s_waitcnt vmcnt(16) lgkmcnt(10)
    ds_read_b64_tr_b16 v[56:57], v9 offset:10272
    ds_read_b64_tr_b16 v[58:59], v9 offset:12832
    v_mfma_f32_16x16x32_bf16 v[16:19], v[64:67], v[80:83], v[16:19]
    s_waitcnt lgkmcnt(10)
    ds_read_b64_tr_b16 v[60:61], v9 offset:10304
    ds_read_b64_tr_b16 v[62:63], v9 offset:12864
    v_mfma_f32_16x16x32_bf16 v[20:23], v[36:39], v[80:83], v[20:23]
    s_waitcnt lgkmcnt(10)
    ds_read_b64_tr_b16 v[64:65], v9 offset:10336
    ds_read_b64_tr_b16 v[66:67], v9 offset:12896
    v_mfma_f32_16x16x32_bf16 v[24:27], v[40:43], v[80:83], v[24:27]
    s_waitcnt lgkmcnt(10)
    ds_read_b64_tr_b16 v[36:37], v9 offset:10368
    ds_read_b64_tr_b16 v[38:39], v9 offset:12928
    v_mfma_f32_16x16x32_bf16 v[28:31], v[44:47], v[80:83], v[28:31]
    s_waitcnt lgkmcnt(10)
    ds_read_b64_tr_b16 v[40:41], v9 offset:15360
    ds_read_b64_tr_b16 v[42:43], v9 offset:17920
    v_mfma_f32_16x16x32_bf16 v[32:35], v[48:51], v[80:83], v[32:35]
    s_waitcnt vmcnt(15) lgkmcnt(10)
    ds_read_b64_tr_b16 v[44:45], v9 offset:15392
    ds_read_b64_tr_b16 v[46:47], v9 offset:17952
    v_mfma_f32_16x16x32_bf16 v[16:19], v[52:55], v[84:87], v[16:19]
    s_waitcnt lgkmcnt(10)
    ds_read_b64_tr_b16 v[48:49], v9 offset:15424
    ds_read_b64_tr_b16 v[50:51], v9 offset:17984
    v_mfma_f32_16x16x32_bf16 v[20:23], v[56:59], v[84:87], v[20:23]
    s_waitcnt lgkmcnt(10)
    ds_read_b64_tr_b16 v[52:53], v9 offset:15456
    ds_read_b64_tr_b16 v[54:55], v9 offset:18016
    v_mfma_f32_16x16x32_bf16 v[24:27], v[60:63], v[84:87], v[24:27]
    s_waitcnt lgkmcnt(10)
    ds_read_b64_tr_b16 v[56:57], v9 offset:15488
    ds_read_b64_tr_b16 v[58:59], v9 offset:18048
    v_mfma_f32_16x16x32_bf16 v[28:31], v[64:67], v[84:87], v[28:31]
    s_waitcnt lgkmcnt(10)
    ds_read_b64_tr_b16 v[60:61], v9 offset:20480
    ds_read_b64_tr_b16 v[62:63], v9 offset:23040
    v_mfma_f32_16x16x32_bf16 v[32:35], v[36:39], v[84:87], v[32:35]
    s_waitcnt vmcnt(14) lgkmcnt(10)
    ds_read_b64_tr_b16 v[64:65], v9 offset:20512
    ds_read_b64_tr_b16 v[66:67], v9 offset:23072
    v_mfma_f32_16x16x32_bf16 v[16:19], v[40:43], v[88:91], v[16:19]
    s_waitcnt lgkmcnt(10)
    ds_read_b64_tr_b16 v[36:37], v9 offset:20544
    ds_read_b64_tr_b16 v[38:39], v9 offset:23104
    v_mfma_f32_16x16x32_bf16 v[20:23], v[44:47], v[88:91], v[20:23]
    s_waitcnt lgkmcnt(10)
    ds_read_b64_tr_b16 v[40:41], v9 offset:20576
    ds_read_b64_tr_b16 v[42:43], v9 offset:23136
    v_mfma_f32_16x16x32_bf16 v[24:27], v[48:51], v[88:91], v[24:27]
    s_waitcnt lgkmcnt(10)
    ds_read_b64_tr_b16 v[44:45], v9 offset:20608
    ds_read_b64_tr_b16 v[46:47], v9 offset:23168
    v_mfma_f32_16x16x32_bf16 v[28:31], v[52:55], v[88:91], v[28:31]
    s_waitcnt lgkmcnt(10)
    ds_read_b64_tr_b16 v[48:49], v9 offset:25600
    ds_read_b64_tr_b16 v[50:51], v9 offset:28160
    v_mfma_f32_16x16x32_bf16 v[32:35], v[56:59], v[88:91], v[32:35]
    s_waitcnt vmcnt(13) lgkmcnt(10)
    ds_read_b64_tr_b16 v[52:53], v9 offset:25632
    ds_read_b64_tr_b16 v[54:55], v9 offset:28192
    v_mfma_f32_16x16x32_bf16 v[16:19], v[60:63], v[92:95], v[16:19]
    s_waitcnt lgkmcnt(10)
    ds_read_b64_tr_b16 v[56:57], v9 offset:25664
    ds_read_b64_tr_b16 v[58:59], v9 offset:28224
    v_mfma_f32_16x16x32_bf16 v[20:23], v[64:67], v[92:95], v[20:23]
    s_waitcnt lgkmcnt(10)
    ds_read_b64_tr_b16 v[60:61], v9 offset:25696
    ds_read_b64_tr_b16 v[62:63], v9 offset:28256
    v_mfma_f32_16x16x32_bf16 v[24:27], v[36:39], v[92:95], v[24:27]
    s_waitcnt lgkmcnt(10)
    ds_read_b64_tr_b16 v[64:65], v9 offset:25728
    ds_read_b64_tr_b16 v[66:67], v9 offset:28288
    v_mfma_f32_16x16x32_bf16 v[28:31], v[40:43], v[92:95], v[28:31]
    s_waitcnt lgkmcnt(10)
    ds_read_b64_tr_b16 v[36:37], v9 offset:30720
    ds_read_b64_tr_b16 v[38:39], v9 offset:33280
    v_mfma_f32_16x16x32_bf16 v[32:35], v[44:47], v[92:95], v[32:35]
    s_waitcnt vmcnt(12) lgkmcnt(10)
    ds_read_b64_tr_b16 v[40:41], v9 offset:30752
    ds_read_b64_tr_b16 v[42:43], v9 offset:33312
    v_mfma_f32_16x16x32_bf16 v[16:19], v[48:51], v[96:99], v[16:19]
    s_waitcnt lgkmcnt(10)
    ds_read_b64_tr_b16 v[44:45], v9 offset:30784
    ds_read_b64_tr_b16 v[46:47], v9 offset:33344
    v_mfma_f32_16x16x32_bf16 v[20:23], v[52:55], v[96:99], v[20:23]
    s_waitcnt lgkmcnt(10)
    ds_read_b64_tr_b16 v[48:49], v9 offset:30816
    ds_read_b64_tr_b16 v[50:51], v9 offset:33376
    v_mfma_f32_16x16x32_bf16 v[24:27], v[56:59], v[96:99], v[24:27]
    s_waitcnt lgkmcnt(10)
    ds_read_b64_tr_b16 v[52:53], v9 offset:30848
    ds_read_b64_tr_b16 v[54:55], v9 offset:33408
    v_mfma_f32_16x16x32_bf16 v[28:31], v[60:63], v[96:99], v[28:31]
    s_waitcnt lgkmcnt(10)
    ds_read_b64_tr_b16 v[56:57], v9 offset:35840
    ds_read_b64_tr_b16 v[58:59], v9 offset:38400
    v_mfma_f32_16x16x32_bf16 v[32:35], v[64:67], v[96:99], v[32:35]
    s_waitcnt vmcnt(11) lgkmcnt(10)
    ds_read_b64_tr_b16 v[60:61], v9 offset:35872
    ds_read_b64_tr_b16 v[62:63], v9 offset:38432
    v_mfma_f32_16x16x32_bf16 v[16:19], v[36:39], v[100:103], v[16:19]
    s_waitcnt lgkmcnt(10)
    ds_read_b64_tr_b16 v[64:65], v9 offset:35904
    ds_read_b64_tr_b16 v[66:67], v9 offset:38464
    v_mfma_f32_16x16x32_bf16 v[20:23], v[40:43], v[100:103], v[20:23]
    s_waitcnt lgkmcnt(10)
    ds_read_b64_tr_b16 v[36:37], v9 offset:35936
    ds_read_b64_tr_b16 v[38:39], v9 offset:38496
    v_mfma_f32_16x16x32_bf16 v[24:27], v[44:47], v[100:103], v[24:27]
    s_waitcnt lgkmcnt(10)
    ds_read_b64_tr_b16 v[40:41], v9 offset:35968
    ds_read_b64_tr_b16 v[42:43], v9 offset:38528
    v_mfma_f32_16x16x32_bf16 v[28:31], v[48:51], v[100:103], v[28:31]
    s_waitcnt lgkmcnt(10)
    ds_read_b64_tr_b16 v[44:45], v8 offset:0
    ds_read_b64_tr_b16 v[46:47], v8 offset:2560
    v_mfma_f32_16x16x32_bf16 v[32:35], v[52:55], v[100:103], v[32:35]
    s_waitcnt vmcnt(10) lgkmcnt(10)
    ds_read_b64_tr_b16 v[48:49], v8 offset:32
    ds_read_b64_tr_b16 v[50:51], v8 offset:2592
    v_mfma_f32_16x16x32_bf16 v[16:19], v[56:59], v[104:107], v[16:19]
    s_waitcnt lgkmcnt(10)
    ds_read_b64_tr_b16 v[52:53], v8 offset:64
    ds_read_b64_tr_b16 v[54:55], v8 offset:2624
    v_mfma_f32_16x16x32_bf16 v[20:23], v[60:63], v[104:107], v[20:23]
    s_waitcnt lgkmcnt(10)
    ds_read_b64_tr_b16 v[56:57], v8 offset:96
    ds_read_b64_tr_b16 v[58:59], v8 offset:2656
    v_mfma_f32_16x16x32_bf16 v[24:27], v[64:67], v[104:107], v[24:27]
    s_waitcnt lgkmcnt(10)
    ds_read_b64_tr_b16 v[60:61], v8 offset:128
    ds_read_b64_tr_b16 v[62:63], v8 offset:2688
    v_mfma_f32_16x16x32_bf16 v[28:31], v[36:39], v[104:107], v[28:31]
    s_waitcnt lgkmcnt(10)
    ds_read_b64_tr_b16 v[64:65], v8 offset:5120
    ds_read_b64_tr_b16 v[66:67], v8 offset:7680
    v_mfma_f32_16x16x32_bf16 v[32:35], v[40:43], v[104:107], v[32:35]
    s_waitcnt vmcnt(9) lgkmcnt(10)
    ds_read_b64_tr_b16 v[36:37], v8 offset:5152
    ds_read_b64_tr_b16 v[38:39], v8 offset:7712
    v_mfma_f32_16x16x32_bf16 v[16:19], v[44:47], v[108:111], v[16:19]
    s_waitcnt lgkmcnt(10)
    ds_read_b64_tr_b16 v[40:41], v8 offset:5184
    ds_read_b64_tr_b16 v[42:43], v8 offset:7744
    v_mfma_f32_16x16x32_bf16 v[20:23], v[48:51], v[108:111], v[20:23]
    s_waitcnt lgkmcnt(10)
    ds_read_b64_tr_b16 v[44:45], v8 offset:5216
    ds_read_b64_tr_b16 v[46:47], v8 offset:7776
    v_mfma_f32_16x16x32_bf16 v[24:27], v[52:55], v[108:111], v[24:27]
    s_waitcnt lgkmcnt(10)
    ds_read_b64_tr_b16 v[48:49], v8 offset:5248
    ds_read_b64_tr_b16 v[50:51], v8 offset:7808
    v_mfma_f32_16x16x32_bf16 v[28:31], v[56:59], v[108:111], v[28:31]
    s_waitcnt lgkmcnt(10)
    ds_read_b64_tr_b16 v[52:53], v8 offset:10240
    ds_read_b64_tr_b16 v[54:55], v8 offset:12800
    v_mfma_f32_16x16x32_bf16 v[32:35], v[60:63], v[108:111], v[32:35]
    s_waitcnt vmcnt(8) lgkmcnt(10)
    ds_read_b64_tr_b16 v[56:57], v8 offset:10272
    ds_read_b64_tr_b16 v[58:59], v8 offset:12832
    v_mfma_f32_16x16x32_bf16 v[16:19], v[64:67], v[112:115], v[16:19]
    s_waitcnt lgkmcnt(10)
    ds_read_b64_tr_b16 v[60:61], v8 offset:10304
    ds_read_b64_tr_b16 v[62:63], v8 offset:12864
    v_mfma_f32_16x16x32_bf16 v[20:23], v[36:39], v[112:115], v[20:23]
    s_waitcnt lgkmcnt(10)
    ds_read_b64_tr_b16 v[64:65], v8 offset:10336
    ds_read_b64_tr_b16 v[66:67], v8 offset:12896
    v_mfma_f32_16x16x32_bf16 v[24:27], v[40:43], v[112:115], v[24:27]
    s_waitcnt lgkmcnt(10)
    ds_read_b64_tr_b16 v[36:37], v8 offset:10368
    ds_read_b64_tr_b16 v[38:39], v8 offset:12928
    v_mfma_f32_16x16x32_bf16 v[28:31], v[44:47], v[112:115], v[28:31]
    s_waitcnt lgkmcnt(10)
    ds_read_b64_tr_b16 v[40:41], v8 offset:15360
    ds_read_b64_tr_b16 v[42:43], v8 offset:17920
    v_mfma_f32_16x16x32_bf16 v[32:35], v[48:51], v[112:115], v[32:35]
    s_waitcnt vmcnt(7) lgkmcnt(10)
    ds_read_b64_tr_b16 v[44:45], v8 offset:15392
    ds_read_b64_tr_b16 v[46:47], v8 offset:17952
    v_mfma_f32_16x16x32_bf16 v[16:19], v[52:55], v[116:119], v[16:19]
    s_waitcnt lgkmcnt(10)
    ds_read_b64_tr_b16 v[48:49], v8 offset:15424
    ds_read_b64_tr_b16 v[50:51], v8 offset:17984
    v_mfma_f32_16x16x32_bf16 v[20:23], v[56:59], v[116:119], v[20:23]
    s_waitcnt lgkmcnt(10)
    ds_read_b64_tr_b16 v[52:53], v8 offset:15456
    ds_read_b64_tr_b16 v[54:55], v8 offset:18016
    v_mfma_f32_16x16x32_bf16 v[24:27], v[60:63], v[116:119], v[24:27]
    s_waitcnt lgkmcnt(10)
    ds_read_b64_tr_b16 v[56:57], v8 offset:15488
    ds_read_b64_tr_b16 v[58:59], v8 offset:18048
    v_mfma_f32_16x16x32_bf16 v[28:31], v[64:67], v[116:119], v[28:31]
    s_waitcnt lgkmcnt(10)
    ds_read_b64_tr_b16 v[60:61], v8 offset:20480
    ds_read_b64_tr_b16 v[62:63], v8 offset:23040
    v_mfma_f32_16x16x32_bf16 v[32:35], v[36:39], v[116:119], v[32:35]
    s_waitcnt vmcnt(6) lgkmcnt(10)
    ds_read_b64_tr_b16 v[64:65], v8 offset:20512
    ds_read_b64_tr_b16 v[66:67], v8 offset:23072
    v_mfma_f32_16x16x32_bf16 v[16:19], v[40:43], v[120:123], v[16:19]
    s_waitcnt lgkmcnt(10)
    ds_read_b64_tr_b16 v[36:37], v8 offset:20544
    ds_read_b64_tr_b16 v[38:39], v8 offset:23104
    v_mfma_f32_16x16x32_bf16 v[20:23], v[44:47], v[120:123], v[20:23]
    s_waitcnt lgkmcnt(10)
    ds_read_b64_tr_b16 v[40:41], v8 offset:20576
    ds_read_b64_tr_b16 v[42:43], v8 offset:23136
    v_mfma_f32_16x16x32_bf16 v[24:27], v[48:51], v[120:123], v[24:27]
    s_waitcnt lgkmcnt(10)
    ds_read_b64_tr_b16 v[44:45], v8 offset:20608
    ds_read_b64_tr_b16 v[46:47], v8 offset:23168
    v_mfma_f32_16x16x32_bf16 v[28:31], v[52:55], v[120:123], v[28:31]
    s_waitcnt lgkmcnt(10)
    ds_read_b64_tr_b16 v[48:49], v8 offset:25600
    ds_read_b64_tr_b16 v[50:51], v8 offset:28160
    v_mfma_f32_16x16x32_bf16 v[32:35], v[56:59], v[120:123], v[32:35]
    s_waitcnt vmcnt(5) lgkmcnt(10)
    ds_read_b64_tr_b16 v[52:53], v8 offset:25632
    ds_read_b64_tr_b16 v[54:55], v8 offset:28192
    v_mfma_f32_16x16x32_bf16 v[16:19], v[60:63], v[124:127], v[16:19]
    s_waitcnt lgkmcnt(10)
    ds_read_b64_tr_b16 v[56:57], v8 offset:25664
    ds_read_b64_tr_b16 v[58:59], v8 offset:28224
    v_mfma_f32_16x16x32_bf16 v[20:23], v[64:67], v[124:127], v[20:23]
    s_waitcnt lgkmcnt(10)
    ds_read_b64_tr_b16 v[60:61], v8 offset:25696
    ds_read_b64_tr_b16 v[62:63], v8 offset:28256
    v_mfma_f32_16x16x32_bf16 v[24:27], v[36:39], v[124:127], v[24:27]
    s_waitcnt lgkmcnt(10)
    ds_read_b64_tr_b16 v[64:65], v8 offset:25728
    ds_read_b64_tr_b16 v[66:67], v8 offset:28288
    v_mfma_f32_16x16x32_bf16 v[28:31], v[40:43], v[124:127], v[28:31]
    s_waitcnt lgkmcnt(10)
    ds_read_b64_tr_b16 v[36:37], v15 offset:0
    ds_read_b64_tr_b16 v[38:39], v15 offset:2560
    v_mfma_f32_16x16x32_bf16 v[32:35], v[44:47], v[124:127], v[32:35]
    s_waitcnt vmcnt(4) lgkmcnt(10)
    ds_read_b64_tr_b16 v[40:41], v15 offset:32
    ds_read_b64_tr_b16 v[42:43], v15 offset:2592
    v_mfma_f32_16x16x32_bf16 v[16:19], v[48:51], v[128:131], v[16:19]
    s_waitcnt lgkmcnt(10)
    ds_read_b64_tr_b16 v[44:45], v15 offset:64
    ds_read_b64_tr_b16 v[46:47], v15 offset:2624
    v_mfma_f32_16x16x32_bf16 v[20:23], v[52:55], v[128:131], v[20:23]
    s_waitcnt lgkmcnt(10)
    ds_read_b64_tr_b16 v[48:49], v15 offset:96
    ds_read_b64_tr_b16 v[50:51], v15 offset:2656
    v_mfma_f32_16x16x32_bf16 v[24:27], v[56:59], v[128:131], v[24:27]
    s_waitcnt lgkmcnt(10)
    ds_read_b64_tr_b16 v[52:53], v15 offset:128
    ds_read_b64_tr_b16 v[54:55], v15 offset:2688
    v_mfma_f32_16x16x32_bf16 v[28:31], v[60:63], v[128:131], v[28:31]
    s_waitcnt lgkmcnt(10)
    ds_read_b64_tr_b16 v[56:57], v15 offset:5120
    ds_read_b64_tr_b16 v[58:59], v15 offset:7680
    v_mfma_f32_16x16x32_bf16 v[32:35], v[64:67], v[128:131], v[32:35]
    s_waitcnt vmcnt(3) lgkmcnt(10)
    ds_read_b64_tr_b16 v[60:61], v15 offset:5152
    ds_read_b64_tr_b16 v[62:63], v15 offset:7712
    v_mfma_f32_16x16x32_bf16 v[16:19], v[36:39], v[132:135], v[16:19]
    s_waitcnt lgkmcnt(10)
    ds_read_b64_tr_b16 v[64:65], v15 offset:5184
    ds_read_b64_tr_b16 v[66:67], v15 offset:7744
    v_mfma_f32_16x16x32_bf16 v[20:23], v[40:43], v[132:135], v[20:23]
    s_waitcnt lgkmcnt(10)
    ds_read_b64_tr_b16 v[36:37], v15 offset:5216
    ds_read_b64_tr_b16 v[38:39], v15 offset:7776
    v_mfma_f32_16x16x32_bf16 v[24:27], v[44:47], v[132:135], v[24:27]
    s_waitcnt lgkmcnt(10)
    ds_read_b64_tr_b16 v[40:41], v15 offset:5248
    ds_read_b64_tr_b16 v[42:43], v15 offset:7808
    v_mfma_f32_16x16x32_bf16 v[28:31], v[48:51], v[132:135], v[28:31]
    s_waitcnt lgkmcnt(10)
    ds_read_b64_tr_b16 v[44:45], v15 offset:10240
    ds_read_b64_tr_b16 v[46:47], v15 offset:12800
    v_mfma_f32_16x16x32_bf16 v[32:35], v[52:55], v[132:135], v[32:35]
    s_waitcnt vmcnt(2) lgkmcnt(10)
    ds_read_b64_tr_b16 v[48:49], v15 offset:10272
    ds_read_b64_tr_b16 v[50:51], v15 offset:12832
    v_mfma_f32_16x16x32_bf16 v[16:19], v[56:59], v[136:139], v[16:19]
    s_waitcnt lgkmcnt(10)
    ds_read_b64_tr_b16 v[52:53], v15 offset:10304
    ds_read_b64_tr_b16 v[54:55], v15 offset:12864
    v_mfma_f32_16x16x32_bf16 v[20:23], v[60:63], v[136:139], v[20:23]
    s_waitcnt lgkmcnt(10)
    ds_read_b64_tr_b16 v[56:57], v15 offset:10336
    ds_read_b64_tr_b16 v[58:59], v15 offset:12896
    v_mfma_f32_16x16x32_bf16 v[24:27], v[64:67], v[136:139], v[24:27]
    s_waitcnt lgkmcnt(10)
    ds_read_b64_tr_b16 v[60:61], v15 offset:10368
    ds_read_b64_tr_b16 v[62:63], v15 offset:12928
    v_mfma_f32_16x16x32_bf16 v[28:31], v[36:39], v[136:139], v[28:31]
    s_waitcnt lgkmcnt(10)
    ds_read_b64_tr_b16 v[64:65], v15 offset:15360
    ds_read_b64_tr_b16 v[66:67], v15 offset:17920
    v_mfma_f32_16x16x32_bf16 v[32:35], v[40:43], v[136:139], v[32:35]
    s_waitcnt vmcnt(1) lgkmcnt(10)
    ds_read_b64_tr_b16 v[36:37], v15 offset:15392
    ds_read_b64_tr_b16 v[38:39], v15 offset:17952
    v_mfma_f32_16x16x32_bf16 v[16:19], v[44:47], v[140:143], v[16:19]
    s_waitcnt lgkmcnt(10)
    ds_read_b64_tr_b16 v[40:41], v15 offset:15424
    ds_read_b64_tr_b16 v[42:43], v15 offset:17984
    v_mfma_f32_16x16x32_bf16 v[20:23], v[48:51], v[140:143], v[20:23]
    s_waitcnt lgkmcnt(10)
    ds_read_b64_tr_b16 v[44:45], v15 offset:15456
    ds_read_b64_tr_b16 v[46:47], v15 offset:18016
    v_mfma_f32_16x16x32_bf16 v[24:27], v[52:55], v[140:143], v[24:27]
    s_waitcnt lgkmcnt(10)
    ds_read_b64_tr_b16 v[48:49], v15 offset:15488
    ds_read_b64_tr_b16 v[50:51], v15 offset:18048
    v_mfma_f32_16x16x32_bf16 v[28:31], v[56:59], v[140:143], v[28:31]
    s_waitcnt lgkmcnt(10)
    v_mfma_f32_16x16x32_bf16 v[32:35], v[60:63], v[140:143], v[32:35]
    s_waitcnt vmcnt(0) lgkmcnt(8)
    v_mfma_f32_16x16x32_bf16 v[16:19], v[64:67], v[144:147], v[16:19]
    s_waitcnt lgkmcnt(6)
    v_mfma_f32_16x16x32_bf16 v[20:23], v[36:39], v[144:147], v[20:23]
    s_waitcnt lgkmcnt(4)
    v_mfma_f32_16x16x32_bf16 v[24:27], v[40:43], v[144:147], v[24:27]
    s_waitcnt lgkmcnt(2)
    v_mfma_f32_16x16x32_bf16 v[28:31], v[44:47], v[144:147], v[28:31]
    s_waitcnt lgkmcnt(0)
    v_mfma_f32_16x16x32_bf16 v[32:35], v[48:51], v[144:147], v[32:35]
    s_nop 7
    s_nop 1
    v_cvt_pk_bf16_f32 v16, v16, v17
    v_cvt_pk_bf16_f32 v17, v18, v19
    buffer_store_dwordx2 v[16:17], v10, s[64:67], 0 offen offset:0
    v_cvt_pk_bf16_f32 v20, v20, v21
    v_cvt_pk_bf16_f32 v21, v22, v23
    buffer_store_dwordx2 v[20:21], v10, s[64:67], 0 offen offset:32
    v_cvt_pk_bf16_f32 v24, v24, v25
    v_cvt_pk_bf16_f32 v25, v26, v27
    buffer_store_dwordx2 v[24:25], v10, s[64:67], 0 offen offset:64
    v_cvt_pk_bf16_f32 v28, v28, v29
    v_cvt_pk_bf16_f32 v29, v30, v31
    buffer_store_dwordx2 v[28:29], v10, s[64:67], 0 offen offset:96
    v_cvt_pk_bf16_f32 v32, v32, v33
    v_cvt_pk_bf16_f32 v33, v34, v35
    buffer_store_dwordx2 v[32:33], v10, s[64:67], 0 offen offset:128
    s_endpgm
.section .rodata,"a"
.p2align 6
.amdhsa_kernel qkv_kernel
  .amdhsa_next_free_vgpr 248
  .amdhsa_next_free_sgpr 96
  .amdhsa_accum_offset 248
  .amdhsa_group_segment_fixed_size 0
  .amdhsa_kernarg_size 88
  .amdhsa_user_sgpr_count 2
  .amdhsa_user_sgpr_kernarg_segment_ptr 1
  .amdhsa_system_sgpr_workgroup_id_x 1
.end_amdhsa_kernel
.p2align 6
.amdhsa_kernel attn_kernel
  .amdhsa_next_free_vgpr 168
  .amdhsa_next_free_sgpr 102
  .amdhsa_accum_offset 168
  .amdhsa_group_segment_fixed_size 0
  .amdhsa_kernarg_size 88
  .amdhsa_user_sgpr_count 2
  .amdhsa_user_sgpr_kernarg_segment_ptr 1
  .amdhsa_system_sgpr_workgroup_id_x 1
.end_amdhsa_kernel
```
